```python
import torch

def _softmax(x, axis=-1):
    return torch.softmax(x, dim=axis)
def _gelu(x):
    return torch.nn.functional.gelu(x, approximate="tanh")
def _silu(x):
    return torch.nn.functional.silu(x)
def _sigmoid(x):
    return torch.sigmoid(x)
def _layernorm(x, axis=-1, eps=1e-5):
    m = x.mean(dim=axis, keepdim=True)
    v = x.var(dim=axis, keepdim=True, unbiased=False)
    return (x - m) / torch.sqrt(v + eps)
def _scatter_add(tgt, idx, src, axis=0):
    return tgt.clone().index_add_(axis, idx, src)
def _segment_sum(src, seg, n):
    out = torch.zeros((n,) + src.shape[1:], dtype=src.dtype)
    return out.index_add_(0, seg, src)
def _pad(x, pw):
    flat = tuple(v for pair in reversed(pw) for v in pair)
    return torch.nn.functional.pad(x, flat)

kernel_name = 'parallel_sum__sliding_block_cached__glu_gated_swiglu__decode'

def setup_inputs():

    _w = (lambda a: (lambda t: t.to(torch.bfloat16) if t.is_floating_point() else t)(torch.as_tensor(a)))
    def _A_setup():
        B, Sq, D = 1, 1, 512
        Hq, Hkv, Sk, Dh = 32, 8, 65536, 128
        assert Hq % Hkv == 0, (Hq, Hkv)
        return {
            "x": _w((lambda *s: torch.randn(*s, dtype=torch.bfloat16) * 0.05)(B, Sq, D)),
            "k_cache": _w((lambda *s: torch.randn(*s, dtype=torch.bfloat16) * 1.6)(B, Hkv, Sk, Dh)),
            "v_cache": _w((lambda *s: torch.randn(*s, dtype=torch.bfloat16) * 0.8)(B, Hkv, Sk, Dh)),
            "wq": _w((lambda *s: torch.randn(*s, dtype=torch.bfloat16) * 1.6)(D, Hq * Dh) * (D ** -0.5)),
            "wo": _w((lambda *s: torch.randn(*s, dtype=torch.bfloat16) * 0.8)(Hq * Dh, D) * ((Hq * Dh) ** -0.5)),
        }
    _A_in = _A_setup()

    def _B_setup():
        B, S, D, F = 1, 1, 512, 1792
        return {
            "x": _w((lambda *s: torch.randn(*s, dtype=torch.bfloat16) * 0.05)(B, S, D)),
            "w1": _w((lambda *s: torch.randn(*s, dtype=torch.bfloat16) * 0.4)(D, F) * (2.0 / D) ** 0.5),
            "w3": _w((lambda *s: torch.randn(*s, dtype=torch.bfloat16) * 0.4)(D, F) * (2.0 / D) ** 0.5),
            "w2": _w((lambda *s: torch.randn(*s, dtype=torch.bfloat16) * 0.4)(F, D) * (2.0 / F) ** 0.5),
        }
    _B_in = _B_setup()

    return {
        "A_x": _A_in["x"],
        "A_k_cache": _A_in["k_cache"],
        "A_v_cache": _A_in["v_cache"],
        "A_wq": _A_in["wq"],
        "A_wo": _A_in["wo"],
        "B_x": _B_in["x"],
        "B_w1": _B_in["w1"],
        "B_w3": _B_in["w3"],
        "B_w2": _B_in["w2"],
    }

def reference(A_x, A_k_cache, A_v_cache, A_wq, A_wo, B_x, B_w1, B_w3, B_w2):
    def _A_ref(x, k_cache, v_cache, wq, wo):
        B, Sq, D = x.shape
        Hq, Dh = 32, 128
        Hkv, Sk = k_cache.shape[1], k_cache.shape[2]
        W = min(4096, max(256, Sk // 4))
        rep = Hq // Hkv
        q = (lambda x, *d: x.permute(*d))((x @ wq).reshape(B, Sq, Hq, Dh), 0, 2, 1, 3)
        k = (lambda x, n, axis: torch.repeat_interleave(x, n, dim=axis))(k_cache[:, :, Sk - W:, :], rep, axis=1)
        v = (lambda x, n, axis: torch.repeat_interleave(x, n, dim=axis))(v_cache[:, :, Sk - W:, :], rep, axis=1)
        scores = torch.einsum("bhqd,bhkd->bhqk", q, k) * (Dh ** -0.5)
        p = _softmax(scores, axis=-1)
        o = torch.einsum("bhqk,bhkd->bhqd", p, v)
        return (lambda x, *d: x.permute(*d))(o, 0, 2, 1, 3).reshape(B, Sq, Hq * Dh) @ wo

    def _B_ref(x, w1, w3, w2):
        gate = torch.einsum("bsd,df->bsf", x, w1)
        up = torch.einsum("bsd,df->bsf", x, w3)
        h = _silu(gate) * up
        out = torch.einsum("bsf,fd->bsd", h, w2)
        return out

    x = A_x
    xn = _layernorm(x, axis=-1)
    return x + _A_ref(xn, A_k_cache, A_v_cache, A_wq, A_wo) + _B_ref(xn, B_w1, B_w3, B_w2)
```

```asm
; @launch grid=(256,1,1) block=(512,1,1) lds=15360
.amdgcn_target "amdgcn-amd-amdhsa--gfx950"
.text
.globl parallel_sum__sliding_block_cached__glu_gated_swiglu__decode_kernel
.p2align 8
.type parallel_sum__sliding_block_cached__glu_gated_swiglu__decode_kernel,@function
parallel_sum__sliding_block_cached__glu_gated_swiglu__decode_kernel:
    s_cmp_ge_u32 s2, 256
    s_cbranch_scc1 L_end
    s_load_dwordx16 s[16:31], s[0:1], 0
    s_load_dwordx8 s[32:39], s[0:1], 64
    s_getpc_b64 s[6:7]
L_pcb_1:
    v_lshlrev_b32 v8, 7, v0
    v_cmp_gt_u32 vcc, L_codeend-L_pcb_1+128, v8
    s_and_b32 s6, s6, 0xffffff80
    s_and_b64 exec, vcc, exec
    global_load_dword v238, v8, s[6:7]
    s_mov_b64 exec, -1
    v_lshrrev_b32 v1, 6, v0
    v_and_b32 v2, 63, v0
    s_and_b32 s4, s2, 7
    v_readfirstlane_b32 s3, v1
    s_lshr_b32 s5, s2, 3
    v_and_b32 v3, 15, v2
    v_lshrrev_b32 v4, 4, v2
    v_lshlrev_b32 v5, 4, v2
    s_cmp_ge_u32 s3, 6
    s_cbranch_scc1 L_pvw
    s_cmp_ge_u32 s3, 4
    s_cselect_b32 s64, 1, 0
    s_cmp_lt_u32 s5, 16
    s_cselect_b32 s65, 1, 0
    s_cmp_lg_u32 s64, s65
    s_cbranch_scc1 L_slow
    s_lshl_b32 s15, s5, 2
    s_add_u32 s15, s15, s3
    s_lshl_b32 s15, s15, 13
    s_lshl_b32 s7, s4, 24
    s_add_u32 s15, s15, s7
    s_add_u32 s15, s15, 15728640
    v_lshrrev_b32 v7, 2, v3
    v_lshlrev_b32 v7, 8, v7
    v_and_b32 v8, 3, v3
    v_lshl_add_u32 v7, v8, 6, v7
    v_lshl_add_u32 v7, v4, 4, v7
    s_lshl_b32 s6, s4, 10
    s_lshl_b32 s7, s5, 6
    s_add_u32 s6, s6, s7
    s_sub_u32 s65, s3, 4
    s_lshl_b32 s7, s65, 21
    s_add_u32 s6, s6, s7
    v_lshrrev_b32 v6, 2, v2
    v_lshlrev_b32 v6, 17, v6
    v_and_b32 v12, 3, v2
    v_lshl_add_u32 v6, v12, 4, v6
    s_movk_i32 s42, 8192
    s_movk_i32 s67, 1024
    s_mov_b32 s43, 0x20000
    s_cmp_eq_u32 s64, 1
    s_cselect_b32 s6, s6, s15
    s_cselect_b32 s67, s42, s67
    s_cselect_b32 s42, 2089024, s42
    s_cselect_b64 vcc, -1, 0
    v_cndmask_b32 v6, v7, v6, vcc
    s_sub_u32 s72, s5, 16
    s_lshl_b32 s72, s72, 1
    s_add_u32 s72, s72, s3
    s_lshl_b32 s72, s72, 17
    s_lshl_b32 s73, s4, 10
    s_add_u32 s72, s72, s73
    v_lshrrev_b32 v12, 3, v2
    v_lshlrev_b32 v12, 13, v12
    v_and_b32 v13, 7, v2
    v_lshl_add_u32 v12, v13, 7, v12
    s_mov_b32 s78, 131072
    s_mov_b32 s79, 0x20000
    s_mov_b32 s74, 65536
    s_waitcnt lgkmcnt(0)
    s_cmp_eq_u32 s64, 1
    s_cselect_b32 s40, s22, s18
    s_cselect_b32 s41, s23, s19
    s_cbranch_scc0 L_fa
    global_load_dwordx4 v[88:91], v5, s[16:17]
    s_branch L_fb
L_fa:
L_fb:
    s_add_u32 s40, s40, s6
    s_addc_u32 s41, s41, 0
    s_mov_b32 s6, 0
    buffer_load_dwordx4 v[16:19], v6, s[40:43], s6 offen nt
    s_add_u32 s6, s6, s67
    buffer_load_dwordx4 v[20:23], v6, s[40:43], s6 offen nt
    s_add_u32 s6, s6, s67
    buffer_load_dwordx4 v[24:27], v6, s[40:43], s6 offen nt
    s_add_u32 s6, s6, s67
    buffer_load_dwordx4 v[28:31], v6, s[40:43], s6 offen nt
    s_add_u32 s6, s6, s67
    buffer_load_dwordx4 v[32:35], v6, s[40:43], s6 offen nt
    s_add_u32 s6, s6, s67
    buffer_load_dwordx4 v[36:39], v6, s[40:43], s6 offen nt
    s_add_u32 s6, s6, s67
    buffer_load_dwordx4 v[40:43], v6, s[40:43], s6 offen nt
    s_add_u32 s6, s6, s67
    buffer_load_dwordx4 v[44:47], v6, s[40:43], s6 offen nt
    s_add_u32 s6, s6, s67
    s_cmp_eq_u32 s64, 0
    s_cbranch_scc1 L_a1
    buffer_load_dwordx4 v[48:51], v6, s[40:43], s6 offen nt
    s_add_u32 s6, s6, s67
    buffer_load_dwordx4 v[52:55], v6, s[40:43], s6 offen nt
    s_add_u32 s6, s6, s67
    buffer_load_dwordx4 v[56:59], v6, s[40:43], s6 offen nt
    s_add_u32 s6, s6, s67
    buffer_load_dwordx4 v[60:63], v6, s[40:43], s6 offen nt
    s_add_u32 s6, s6, s67
    buffer_load_dwordx4 v[64:67], v6, s[40:43], s6 offen nt
    s_add_u32 s6, s6, s67
    buffer_load_dwordx4 v[68:71], v6, s[40:43], s6 offen nt
    s_add_u32 s6, s6, s67
    buffer_load_dwordx4 v[72:75], v6, s[40:43], s6 offen nt
    s_add_u32 s6, s6, s67
    buffer_load_dwordx4 v[76:79], v6, s[40:43], s6 offen nt
    s_setprio 3
    v_mov_b32 v8, 0
    v_mov_b32 v9, 0
    ds_write_b32 v8, v8 offset:3968
    ds_write_b64 v8, v[8:9] offset:3976
    s_load_dword s12, s[38:39], 0
    s_mov_b32 s8, s38
    s_mov_b32 s9, s39
    s_mov_b32 s10, 16777216
    s_mov_b32 s11, 0x20000
    s_lshl_b32 s7, s4, 2
    s_mul_i32 s6, s4, 3
    s_add_u32 s6, s6, 4
    s_cmp_lt_u32 s4, 4
    s_cselect_b32 s57, s7, s6
    s_cselect_b32 s58, 4, 3
    s_sub_u32 s7, s5, 16
    s_lshr_b32 s15, s7, 2
    s_sub_u32 s65, s3, 4
    s_and_b32 s71, s5, 15
    s_lshl_b32 s66, s58, 2
    s_add_u32 s66, s66, 16
    s_cmp_lt_u32 s5, s66
    s_cselect_b32 s64, 1, 0
    s_waitcnt lgkmcnt(0)
    s_barrier
L_u2:
    s_mov_b32 s99, 0
    s_mov_b32 s100, s20
    s_mov_b32 s101, s21
    s_lshr_b32 s68, s5, 3
    s_cmp_lt_u32 s68, s58
    s_cselect_b32 s69, 1, 0
    s_add_u32 s68, s68, s57
    s_lshl_b32 s68, s68, 1
    s_add_u32 s68, s68, s65
    s_lshl_b32 s68, s68, 15
    s_and_b32 s70, s5, 7
    s_lshl_b32 s70, s70, 7
    s_add_u32 s68, s68, s70
    s_cmp_eq_u32 s69, 1
    s_cselect_b32 s68, s68, 0
    s_cselect_b32 s50, 31872, 0
    v_lshrrev_b32 v7, 3, v2
    v_lshlrev_b32 v7, 12, v7
    v_and_b32 v8, 7, v2
    v_lshl_add_u32 v7, v8, 4, v7
    s_add_u32 s28, s32, s68
    s_addc_u32 s29, s33, 0
    s_mov_b32 s30, s50
    s_mov_b32 s31, 0x20000
    s_mul_i32 s6, s4, 1536
    s_mul_i32 s66, s71, 96
    s_add_u32 s6, s6, s66
    s_add_u32 s6, s6, 262144
    s_lshl_b32 s66, s4, 2
    s_add_u32 s66, s66, s15
    s_lshl_b32 s66, s66, 1
    s_and_b32 s70, s7, 1
    s_add_u32 s66, s66, s70
    s_lshl_b32 s66, s66, 8
    s_bfe_u32 s70, s7, 0x10001
    s_lshl_b32 s70, s70, 7
    s_add_u32 s66, s66, s70
    s_add_u32 s66, s66, 655360
    s_cmp_lt_u32 s5, 16
    s_cselect_b32 s26, s6, s66
    s_mov_b32 s15, s64
    s_mov_b32 s18, s34
    s_mov_b32 s19, s35
    v_and_b32 v11, 1, v2
    v_bfe_u32 v12, v2, 1, 2
    v_cmp_eq_u32 vcc, 1, v11
    v_mov_b32 v13, 0x0c0c0100
    v_mov_b32 v14, 0x01000c0c
    v_cndmask_b32 v13, v13, v14, vcc
    v_mov_b32 v14, 0x0c0c0302
    v_mov_b32 v15, 0x03020c0c
    v_cndmask_b32 v14, v14, v15, vcc
    v_mov_b32 v15, 0x0c0c0c0c
    v_cmp_eq_u32 vcc, 0, v12
    s_nop 1
    v_cndmask_b32 v248, v15, v13, vcc
    v_cndmask_b32 v249, v15, v14, vcc
    v_cmp_eq_u32 vcc, 1, v12
    s_nop 1
    v_cndmask_b32 v250, v15, v13, vcc
    v_cndmask_b32 v251, v15, v14, vcc
    v_cmp_eq_u32 vcc, 2, v12
    s_nop 1
    v_cndmask_b32 v252, v15, v13, vcc
    v_cndmask_b32 v253, v15, v14, vcc
    v_cmp_eq_u32 vcc, 3, v12
    s_nop 1
    v_cndmask_b32 v254, v15, v13, vcc
    v_cndmask_b32 v255, v15, v14, vcc
    s_waitcnt vmcnt(16) lgkmcnt(0)
    s_add_u32 s12, s12, 2654435769
    v_lshlrev_b32 v144, 16, v88
    v_and_b32 v145, 0xffff0000, v88
    v_lshlrev_b32 v146, 16, v89
    v_and_b32 v147, 0xffff0000, v89
    v_lshlrev_b32 v148, 16, v90
    v_and_b32 v149, 0xffff0000, v90
    v_lshlrev_b32 v150, 16, v91
    v_and_b32 v151, 0xffff0000, v91
    v_add_f32 v12, v144, v145
    v_add_f32 v13, v146, v147
    v_add_f32 v14, v148, v149
    v_add_f32 v15, v150, v151
    v_add_f32 v12, v12, v13
    v_add_f32 v14, v14, v15
    v_add_f32 v12, v12, v14
    s_nop 1
    v_add_f32_dpp v12, v12, v12 quad_perm:[1,0,3,2] row_mask:0xf bank_mask:0xf
    s_nop 1
    v_add_f32_dpp v12, v12, v12 quad_perm:[2,3,0,1] row_mask:0xf bank_mask:0xf
    s_nop 1
    v_add_f32_dpp v12, v12, v12 row_ror:4 row_mask:0xf bank_mask:0xf
    s_nop 1
    v_add_f32_dpp v12, v12, v12 row_ror:8 row_mask:0xf bank_mask:0xf
    v_mov_b32 v13, v12
    s_nop 1
    v_permlane16_swap_b32 v12, v13
    s_nop 1
    v_add_f32 v12, v12, v13
    v_mov_b32 v13, v12
    s_nop 1
    v_permlane32_swap_b32 v12, v13
    s_nop 1
    v_add_f32 v12, v12, v13
    v_mul_f32 v12, 0x3b000000, v12
    v_sub_f32 v13, v144, v12
    v_mul_f32 v14, v13, v13
    v_sub_f32 v13, v145, v12
    v_fmac_f32 v14, v13, v13
    v_sub_f32 v13, v146, v12
    v_fmac_f32 v14, v13, v13
    v_sub_f32 v13, v147, v12
    v_fmac_f32 v14, v13, v13
    v_sub_f32 v13, v148, v12
    v_fmac_f32 v14, v13, v13
    v_sub_f32 v13, v149, v12
    v_fmac_f32 v14, v13, v13
    v_sub_f32 v13, v150, v12
    v_fmac_f32 v14, v13, v13
    v_sub_f32 v13, v151, v12
    v_fmac_f32 v14, v13, v13
    s_nop 1
    v_add_f32_dpp v14, v14, v14 quad_perm:[1,0,3,2] row_mask:0xf bank_mask:0xf
    s_nop 1
    v_add_f32_dpp v14, v14, v14 quad_perm:[2,3,0,1] row_mask:0xf bank_mask:0xf
    s_nop 1
    v_add_f32_dpp v14, v14, v14 row_ror:4 row_mask:0xf bank_mask:0xf
    s_nop 1
    v_add_f32_dpp v14, v14, v14 row_ror:8 row_mask:0xf bank_mask:0xf
    v_mov_b32 v13, v14
    s_nop 1
    v_permlane16_swap_b32 v14, v13
    s_nop 1
    v_add_f32 v14, v14, v13
    v_mov_b32 v13, v14
    s_nop 1
    v_permlane32_swap_b32 v14, v13
    s_nop 1
    v_add_f32 v14, v14, v13
    v_mul_f32 v14, 0x3b000000, v14
    v_cvt_pk_bf16_f32 v13, v12, v14
    v_lshlrev_b32 v12, 16, v13
    v_and_b32 v14, 0xffff0000, v13
    v_add_f32 v14, 0x3727c5ac, v14
    v_cvt_pk_bf16_f32 v14, v14, v14
    v_lshlrev_b32 v14, 16, v14
    v_sqrt_f32 v14, v14
    s_nop 0
    v_cvt_pk_bf16_f32 v14, v14, v14
    v_lshlrev_b32 v14, 16, v14
    v_rcp_f32 v14, v14
    v_sub_f32 v144, v144, v12
    v_sub_f32 v145, v145, v12
    v_sub_f32 v146, v146, v12
    v_sub_f32 v147, v147, v12
    v_sub_f32 v148, v148, v12
    v_sub_f32 v149, v149, v12
    v_sub_f32 v150, v150, v12
    v_sub_f32 v151, v151, v12
    v_cvt_pk_bf16_f32 v88, v144, v145
    v_cvt_pk_bf16_f32 v89, v146, v147
    v_cvt_pk_bf16_f32 v90, v148, v149
    v_cvt_pk_bf16_f32 v91, v150, v151
    v_lshlrev_b32 v144, 16, v88
    v_and_b32 v145, 0xffff0000, v88
    v_lshlrev_b32 v146, 16, v89
    v_and_b32 v147, 0xffff0000, v89
    v_lshlrev_b32 v148, 16, v90
    v_and_b32 v149, 0xffff0000, v90
    v_lshlrev_b32 v150, 16, v91
    v_and_b32 v151, 0xffff0000, v91
    v_mul_f32 v144, v144, v14
    v_mul_f32 v145, v145, v14
    v_mul_f32 v146, v146, v14
    v_mul_f32 v147, v147, v14
    v_mul_f32 v148, v148, v14
    v_mul_f32 v149, v149, v14
    v_mul_f32 v150, v150, v14
    v_mul_f32 v151, v151, v14
    v_cvt_pk_bf16_f32 v88, v144, v145
    v_cvt_pk_bf16_f32 v89, v146, v147
    v_cvt_pk_bf16_f32 v90, v148, v149
    v_cvt_pk_bf16_f32 v91, v150, v151
    ds_write_b128 v5, v[88:91] offset:1536
    s_lshl_b32 s6, s65, 9
    v_lshlrev_b32 v12, 7, v4
    v_bfe_u32 v13, v2, 3, 1
    v_lshl_add_u32 v12, v13, 5, v12
    v_add_u32 v12, s6, v12
    ds_read_b128 v[224:227], v12 offset:1536
    ds_read_b128 v[228:231], v12 offset:1552
    ds_read_b128 v[232:235], v12 offset:1600
    ds_read_b128 v[236:239], v12 offset:1616
    s_waitcnt lgkmcnt(0)
    v_perm_b32 v96, v224, v224, v248
    v_perm_b32 v97, v224, v224, v250
    v_perm_b32 v98, v224, v224, v252
    v_perm_b32 v99, v224, v224, v254
    v_perm_b32 v100, v232, v232, v248
    v_perm_b32 v101, v232, v232, v250
    v_perm_b32 v102, v232, v232, v252
    v_perm_b32 v103, v232, v232, v254
    v_perm_b32 v104, v224, v224, v249
    v_perm_b32 v105, v224, v224, v251
    v_perm_b32 v106, v224, v224, v253
    v_perm_b32 v107, v224, v224, v255
    v_perm_b32 v108, v232, v232, v249
    v_perm_b32 v109, v232, v232, v251
    v_perm_b32 v110, v232, v232, v253
    v_perm_b32 v111, v232, v232, v255
    v_perm_b32 v112, v225, v225, v248
    v_perm_b32 v113, v225, v225, v250
    v_perm_b32 v114, v225, v225, v252
    v_perm_b32 v115, v225, v225, v254
    v_perm_b32 v116, v233, v233, v248
    v_perm_b32 v117, v233, v233, v250
    v_perm_b32 v118, v233, v233, v252
    v_perm_b32 v119, v233, v233, v254
    v_perm_b32 v120, v225, v225, v249
    v_perm_b32 v121, v225, v225, v251
    v_perm_b32 v122, v225, v225, v253
    v_perm_b32 v123, v225, v225, v255
    v_perm_b32 v124, v233, v233, v249
    v_perm_b32 v125, v233, v233, v251
    v_perm_b32 v126, v233, v233, v253
    v_perm_b32 v127, v233, v233, v255
    v_perm_b32 v128, v226, v226, v248
    v_perm_b32 v129, v226, v226, v250
    v_perm_b32 v130, v226, v226, v252
    v_perm_b32 v131, v226, v226, v254
    v_perm_b32 v132, v234, v234, v248
    v_perm_b32 v133, v234, v234, v250
    v_perm_b32 v134, v234, v234, v252
    v_perm_b32 v135, v234, v234, v254
    v_perm_b32 v136, v226, v226, v249
    v_perm_b32 v137, v226, v226, v251
    v_perm_b32 v138, v226, v226, v253
    v_perm_b32 v139, v226, v226, v255
    v_perm_b32 v140, v234, v234, v249
    v_perm_b32 v141, v234, v234, v251
    v_perm_b32 v142, v234, v234, v253
    v_perm_b32 v143, v234, v234, v255
    v_perm_b32 v144, v227, v227, v248
    v_perm_b32 v145, v227, v227, v250
    v_perm_b32 v146, v227, v227, v252
    v_perm_b32 v147, v227, v227, v254
    v_perm_b32 v148, v235, v235, v248
    v_perm_b32 v149, v235, v235, v250
    v_perm_b32 v150, v235, v235, v252
    v_perm_b32 v151, v235, v235, v254
    v_perm_b32 v152, v227, v227, v249
    v_perm_b32 v153, v227, v227, v251
    v_perm_b32 v154, v227, v227, v253
    v_perm_b32 v155, v227, v227, v255
    v_perm_b32 v156, v235, v235, v249
    v_perm_b32 v157, v235, v235, v251
    v_perm_b32 v158, v235, v235, v253
    v_perm_b32 v159, v235, v235, v255
    v_perm_b32 v160, v228, v228, v248
    v_perm_b32 v161, v228, v228, v250
    v_perm_b32 v162, v228, v228, v252
    v_perm_b32 v163, v228, v228, v254
    v_perm_b32 v164, v236, v236, v248
    v_perm_b32 v165, v236, v236, v250
    v_perm_b32 v166, v236, v236, v252
    v_perm_b32 v167, v236, v236, v254
    v_perm_b32 v168, v228, v228, v249
    v_perm_b32 v169, v228, v228, v251
    v_perm_b32 v170, v228, v228, v253
    v_perm_b32 v171, v228, v228, v255
    v_perm_b32 v172, v236, v236, v249
    v_perm_b32 v173, v236, v236, v251
    v_perm_b32 v174, v236, v236, v253
    v_perm_b32 v175, v236, v236, v255
    v_perm_b32 v176, v229, v229, v248
    v_perm_b32 v177, v229, v229, v250
    v_perm_b32 v178, v229, v229, v252
    v_perm_b32 v179, v229, v229, v254
    v_perm_b32 v180, v237, v237, v248
    v_perm_b32 v181, v237, v237, v250
    v_perm_b32 v182, v237, v237, v252
    v_perm_b32 v183, v237, v237, v254
    v_perm_b32 v184, v229, v229, v249
    v_perm_b32 v185, v229, v229, v251
    v_perm_b32 v186, v229, v229, v253
    v_perm_b32 v187, v229, v229, v255
    v_perm_b32 v188, v237, v237, v249
    v_perm_b32 v189, v237, v237, v251
    v_perm_b32 v190, v237, v237, v253
    v_perm_b32 v191, v237, v237, v255
    v_perm_b32 v192, v230, v230, v248
    v_perm_b32 v193, v230, v230, v250
    v_perm_b32 v194, v230, v230, v252
    v_perm_b32 v195, v230, v230, v254
    v_perm_b32 v196, v238, v238, v248
    v_perm_b32 v197, v238, v238, v250
    v_perm_b32 v198, v238, v238, v252
    v_perm_b32 v199, v238, v238, v254
    v_perm_b32 v200, v230, v230, v249
    v_perm_b32 v201, v230, v230, v251
    v_perm_b32 v202, v230, v230, v253
    v_perm_b32 v203, v230, v230, v255
    v_perm_b32 v204, v238, v238, v249
    v_perm_b32 v205, v238, v238, v251
    v_perm_b32 v206, v238, v238, v253
    v_perm_b32 v207, v238, v238, v255
    v_perm_b32 v208, v231, v231, v248
    v_perm_b32 v209, v231, v231, v250
    v_perm_b32 v210, v231, v231, v252
    v_perm_b32 v211, v231, v231, v254
    v_perm_b32 v212, v239, v239, v248
    v_perm_b32 v213, v239, v239, v250
    v_perm_b32 v214, v239, v239, v252
    v_perm_b32 v215, v239, v239, v254
    v_perm_b32 v216, v231, v231, v249
    v_perm_b32 v217, v231, v231, v251
    v_perm_b32 v218, v231, v231, v253
    v_perm_b32 v219, v231, v231, v255
    v_perm_b32 v220, v239, v239, v249
    v_perm_b32 v221, v239, v239, v251
    v_perm_b32 v222, v239, v239, v253
    v_perm_b32 v223, v239, v239, v255
    s_cmp_ge_u32 s5, 16
    s_cbranch_scc1 L_uB1
L_ucomp:
    s_sub_u32 s6, s3, 4
    s_lshl_b32 s6, s6, 9
    v_lshrrev_b32 v12, 2, v3
    v_lshlrev_b32 v12, 7, v12
    v_and_b32 v13, 3, v3
    v_lshl_add_u32 v12, v13, 5, v12
    v_and_b32 v13, 1, v4
    v_lshl_add_u32 v12, v13, 4, v12
    v_add_u32 v12, s6, v12
    v_and_b32 v11, 7, v2
    v_lshlrev_b32 v11, 7, v11
    v_lshrrev_b32 v13, 3, v2
    v_lshl_add_u32 v11, v13, 4, v11
    v_lshlrev_b32 v13, 3, v13
    v_mul_u32_u24 v14, 43, v2
    v_lshrrev_b32 v14, 8, v14
    v_mul_u32_u24 v15, 6, v14
    v_sub_u32 v15, v2, v15
    v_lshlrev_b32 v9, 14, v14
    v_lshl_add_u32 v9, v15, 4, v9
    v_mul_u32_u24 v10, 12, v15
    v_add_u32 v10, 3584, v10
    s_mov_b32 s6, 0xff00ff00
    s_mov_b32 s7, 0xff00ff00
    s_waitcnt vmcnt(15)
    v_mfma_f32_16x16x32_bf16 v[224:227], v[96:99], v[16:19], 0
    v_mfma_f32_16x16x32_bf16 v[228:231], v[100:103], v[16:19], 0
    s_waitcnt vmcnt(14)
    v_mfma_f32_16x16x32_bf16 v[224:227], v[104:107], v[20:23], v[224:227]
    v_mfma_f32_16x16x32_bf16 v[228:231], v[108:111], v[20:23], v[228:231]
    s_waitcnt vmcnt(13)
    v_mfma_f32_16x16x32_bf16 v[224:227], v[112:115], v[24:27], v[224:227]
    v_mfma_f32_16x16x32_bf16 v[228:231], v[116:119], v[24:27], v[228:231]
    s_waitcnt vmcnt(12)
    v_mfma_f32_16x16x32_bf16 v[224:227], v[120:123], v[28:31], v[224:227]
    v_mfma_f32_16x16x32_bf16 v[228:231], v[124:127], v[28:31], v[228:231]
    s_waitcnt vmcnt(11)
    v_mfma_f32_16x16x32_bf16 v[224:227], v[128:131], v[32:35], v[224:227]
    v_mfma_f32_16x16x32_bf16 v[228:231], v[132:135], v[32:35], v[228:231]
    s_waitcnt vmcnt(10)
    v_mfma_f32_16x16x32_bf16 v[224:227], v[136:139], v[36:39], v[224:227]
    v_mfma_f32_16x16x32_bf16 v[228:231], v[140:143], v[36:39], v[228:231]
    s_waitcnt vmcnt(9)
    v_mfma_f32_16x16x32_bf16 v[224:227], v[144:147], v[40:43], v[224:227]
    v_mfma_f32_16x16x32_bf16 v[228:231], v[148:151], v[40:43], v[228:231]
    s_waitcnt vmcnt(8)
    v_mfma_f32_16x16x32_bf16 v[224:227], v[152:155], v[44:47], v[224:227]
    v_mfma_f32_16x16x32_bf16 v[228:231], v[156:159], v[44:47], v[228:231]
    s_waitcnt vmcnt(7)
    v_mfma_f32_16x16x32_bf16 v[224:227], v[160:163], v[48:51], v[224:227]
    v_mfma_f32_16x16x32_bf16 v[228:231], v[164:167], v[48:51], v[228:231]
    s_waitcnt vmcnt(6)
    v_mfma_f32_16x16x32_bf16 v[224:227], v[168:171], v[52:55], v[224:227]
    v_mfma_f32_16x16x32_bf16 v[228:231], v[172:175], v[52:55], v[228:231]
    s_waitcnt vmcnt(5)
    v_mfma_f32_16x16x32_bf16 v[224:227], v[176:179], v[56:59], v[224:227]
    v_mfma_f32_16x16x32_bf16 v[228:231], v[180:183], v[56:59], v[228:231]
    s_waitcnt vmcnt(4)
    v_mfma_f32_16x16x32_bf16 v[224:227], v[184:187], v[60:63], v[224:227]
    v_mfma_f32_16x16x32_bf16 v[228:231], v[188:191], v[60:63], v[228:231]
    s_waitcnt vmcnt(3)
    v_mfma_f32_16x16x32_bf16 v[224:227], v[192:195], v[64:67], v[224:227]
    v_mfma_f32_16x16x32_bf16 v[228:231], v[196:199], v[64:67], v[228:231]
    s_waitcnt vmcnt(2)
    v_mfma_f32_16x16x32_bf16 v[224:227], v[200:203], v[68:71], v[224:227]
    v_mfma_f32_16x16x32_bf16 v[228:231], v[204:207], v[68:71], v[228:231]
    s_waitcnt vmcnt(1)
    v_mfma_f32_16x16x32_bf16 v[224:227], v[208:211], v[72:75], v[224:227]
    v_mfma_f32_16x16x32_bf16 v[228:231], v[212:215], v[72:75], v[228:231]
    s_waitcnt vmcnt(0)
    v_mfma_f32_16x16x32_bf16 v[224:227], v[216:219], v[76:79], v[224:227]
    v_mfma_f32_16x16x32_bf16 v[228:231], v[220:223], v[76:79], v[228:231]
    s_mov_b32 s20, 0x0f0f0f0f
    s_mov_b32 s21, 0xf0f0f0f0
    v_mov_b32 v8, 0
    v_mov_b32 v14, 1
    s_add_u32 s22, s26, 327680
    s_nop 4
    v_cndmask_b32 v224, v224, v228, s[6:7]
    v_cndmask_b32 v225, v225, v229, s[6:7]
    v_cndmask_b32 v226, v226, v230, s[6:7]
    v_cndmask_b32 v227, v227, v231, s[6:7]
    s_mov_b64 exec, s[20:21]
    ds_write_b128 v12, v[224:227] offset:2560
    s_mov_b64 exec, -1
    s_cmp_eq_u32 s3, 4
    s_cbranch_scc1 L_w4_3
    ds_write_b32 v8, v14 offset:3968
    s_branch L_nopub_2
L_w4_3:
    s_cmp_eq_u32 s15, 0
    s_cbranch_scc1 L_nopub_2
    s_mov_b32 s24, 20000
L_fl_4:
    ds_read_b32 v14, v8 offset:3968
    ds_read_b128 v[224:227], v11 offset:2560
    s_waitcnt lgkmcnt(1)
    v_readfirstlane_b32 s25, v14
    s_cmp_eq_u32 s25, 1
    s_cbranch_scc1 L_flok_5
    s_sub_u32 s24, s24, 1
    s_cmp_lg_u32 s24, 0
    s_cbranch_scc1 L_fl_4
L_flok_5:
    s_waitcnt lgkmcnt(0)
    v_add_f32_dpp v224, v224, v224 quad_perm:[1,0,3,2] row_mask:0xf bank_mask:0xf
    v_add_f32_dpp v225, v225, v225 quad_perm:[1,0,3,2] row_mask:0xf bank_mask:0xf
    v_add_f32_dpp v226, v226, v226 quad_perm:[1,0,3,2] row_mask:0xf bank_mask:0xf
    v_add_f32_dpp v227, v227, v227 quad_perm:[1,0,3,2] row_mask:0xf bank_mask:0xf
    v_add_f32_dpp v224, v224, v224 quad_perm:[2,3,0,1] row_mask:0xf bank_mask:0xf
    v_add_f32_dpp v225, v225, v225 quad_perm:[2,3,0,1] row_mask:0xf bank_mask:0xf
    v_add_f32_dpp v226, v226, v226 quad_perm:[2,3,0,1] row_mask:0xf bank_mask:0xf
    v_add_f32_dpp v227, v227, v227 quad_perm:[2,3,0,1] row_mask:0xf bank_mask:0xf
    v_add_f32_dpp v224, v224, v224 row_half_mirror row_mask:0xf bank_mask:0xf
    v_add_f32_dpp v225, v225, v225 row_half_mirror row_mask:0xf bank_mask:0xf
    v_add_f32_dpp v226, v226, v226 row_half_mirror row_mask:0xf bank_mask:0xf
    v_add_f32_dpp v227, v227, v227 row_half_mirror row_mask:0xf bank_mask:0xf
    v_cvt_pk_bf16_f32 v224, v224, v225
    v_cvt_pk_bf16_f32 v225, v226, v227
    ds_write_b64 v13, v[224:225] offset:3584
    ds_read2_b32 v[224:225], v10 offset0:0 offset1:1
    ds_read_b32 v226, v10 offset:8
    v_mov_b32 v227, s12
    s_mov_b32 exec_hi, 0x0fffffff
    s_waitcnt lgkmcnt(0)
    buffer_store_dwordx4 v[224:227], v9, s[8:11], s26 offen
    s_add_u32 s23, s26, 163840
    buffer_store_dwordx4 v[224:227], v9, s[8:11], s23 offen
    s_mov_b64 exec, 0x3f
    buffer_store_dwordx4 v[224:227], v9, s[8:11], s22 offen sc1
    s_mov_b64 exec, -1
L_nopub_2:
    s_cmp_ge_u32 s5, 16
    s_cbranch_scc1 L_uafter
L_uB1:
    s_barrier
    s_mov_b32 s98, s3
L_c1:
    s_mul_i32 s20, s4, 1536
    s_lshl_b32 s6, s98, 8
    s_add_u32 s20, s20, s6
    s_add_u32 s20, s20, 262144
    s_mul_i32 s6, s98, 48
    v_add_u32 v8, s6, v2
    v_mul_u32_u24 v9, 3641, v8
    v_lshrrev_b32 v9, 16, v9
    v_mul_u32_u24 v10, 18, v9
    v_sub_u32 v10, v8, v10
    v_lshlrev_b32 v9, 1, v9
    v_sub_u32 v8, v8, v9
    v_cmp_gt_u32 vcc, 16, v10
    v_mov_b32 v9, 288
    s_nop 0
    v_cndmask_b32 v8, v9, v8, vcc
    v_lshlrev_b32 v8, 2, v8
    v_mov_b32 v13, s98
    v_mov_b32 v14, 1
    v_and_b32 v10, 3, v2
    v_lshlrev_b32 v11, 8, v10
    v_bfe_u32 v12, v2, 2, 2
    v_lshl_add_u32 v11, v12, 6, v11
    v_lshl_add_u32 v11, v4, 4, v11
    s_mov_b32 s21, 20
    s_add_u32 s22, s8, s20
    s_addc_u32 s23, s9, 0
    s_branch L_q_6
L_qrt_10:
    s_sub_u32 s21, s21, 1
    s_cmp_eq_u32 s21, 0
    s_cbranch_scc1 L_qr_9
L_q_6:
    s_load_dwordx16 s[32:47], s[22:23], 0
    s_load_dwordx16 s[48:63], s[22:23], 64
    s_load_dwordx16 s[64:79], s[22:23], 128
    s_load_dwordx16 s[80:95], s[22:23], 192
    s_add_u32 s22, s22, 16384
    s_addc_u32 s23, s23, 0
    s_waitcnt lgkmcnt(0)
    s_cmp_lg_u32 s35, s12
    s_cbranch_scc1 L_qrt_10
    s_cmp_lg_u32 s59, s12
    s_cbranch_scc1 L_qrt_10
    s_cmp_lg_u32 s83, s12
    s_cbranch_scc1 L_qrt_10
    s_cmp_lg_u32 s95, s12
    s_cbranch_scc1 L_qrt_10
    s_xor_b32 s24, s39, s12
    s_xor_b32 s25, s43, s12
    s_or_b32 s24, s24, s25
    s_xor_b32 s25, s47, s12
    s_or_b32 s24, s24, s25
    s_xor_b32 s25, s51, s12
    s_or_b32 s24, s24, s25
    s_xor_b32 s25, s55, s12
    s_or_b32 s24, s24, s25
    s_xor_b32 s25, s63, s12
    s_or_b32 s24, s24, s25
    s_xor_b32 s25, s67, s12
    s_or_b32 s24, s24, s25
    s_xor_b32 s25, s71, s12
    s_or_b32 s24, s24, s25
    s_xor_b32 s25, s75, s12
    s_or_b32 s24, s24, s25
    s_xor_b32 s25, s79, s12
    s_or_b32 s24, s24, s25
    s_xor_b32 s25, s87, s12
    s_or_b32 s24, s24, s25
    s_xor_b32 s25, s91, s12
    s_or_b32 s24, s24, s25
    s_cmp_eq_u32 s24, 0
    s_cbranch_scc0 L_qrt_10
L_qok_7:
    v_writelane_b32 v9, s32, 0
    v_writelane_b32 v9, s33, 1
    v_writelane_b32 v9, s34, 2
    v_writelane_b32 v9, s36, 3
    v_writelane_b32 v9, s37, 4
    v_writelane_b32 v9, s38, 5
    v_writelane_b32 v9, s40, 6
    v_writelane_b32 v9, s41, 7
    v_writelane_b32 v9, s42, 8
    v_writelane_b32 v9, s44, 9
    v_writelane_b32 v9, s45, 10
    v_writelane_b32 v9, s46, 11
    v_writelane_b32 v9, s48, 12
    v_writelane_b32 v9, s49, 13
    v_writelane_b32 v9, s50, 14
    v_writelane_b32 v9, s52, 15
    v_writelane_b32 v9, s53, 16
    v_writelane_b32 v9, s54, 17
    v_writelane_b32 v9, s56, 18
    v_writelane_b32 v9, s57, 19
    v_writelane_b32 v9, s58, 20
    v_writelane_b32 v9, s60, 21
    v_writelane_b32 v9, s61, 22
    v_writelane_b32 v9, s62, 23
    v_writelane_b32 v9, s64, 24
    v_writelane_b32 v9, s65, 25
    v_writelane_b32 v9, s66, 26
    v_writelane_b32 v9, s68, 27
    v_writelane_b32 v9, s69, 28
    v_writelane_b32 v9, s70, 29
    v_writelane_b32 v9, s72, 30
    v_writelane_b32 v9, s73, 31
    v_writelane_b32 v9, s74, 32
    v_writelane_b32 v9, s76, 33
    v_writelane_b32 v9, s77, 34
    v_writelane_b32 v9, s78, 35
    v_writelane_b32 v9, s80, 36
    v_writelane_b32 v9, s81, 37
    v_writelane_b32 v9, s82, 38
    v_writelane_b32 v9, s84, 39
    v_writelane_b32 v9, s85, 40
    v_writelane_b32 v9, s86, 41
    v_writelane_b32 v9, s88, 42
    v_writelane_b32 v9, s89, 43
    v_writelane_b32 v9, s90, 44
    v_writelane_b32 v9, s92, 45
    v_writelane_b32 v9, s93, 46
    v_writelane_b32 v9, s94, 47
    s_mov_b32 exec_hi, 0xffff
    ds_write_b32 v8, v9 offset:0
    s_mov_b64 exec, 1
    ds_write_b8 v13, v14 offset:3976
    s_mov_b64 exec, -1
    s_cmp_ge_u32 s3, 4
    s_cbranch_scc1 L_umid
L_amid:
    s_mov_b32 s6, 0x01010101
    s_mov_b32 s7, 0x0101
    v_mov_b32 v13, 0
    s_mov_b32 s24, 20000
L_qp:
    ds_read_b64 v[14:15], v13 offset:3976
    ds_read_b128 v[96:99], v11 offset:0
    s_waitcnt lgkmcnt(0)
    v_cmp_ne_u64 vcc, s[6:7], v[14:15]
    s_nop 1
    s_cmp_eq_u64 vcc, 0
    s_cbranch_scc1 L_qpok
    s_sub_u32 s24, s24, 1
    s_cmp_lg_u32 s24, 0
    s_cbranch_scc1 L_qp
L_qpok:
    s_waitcnt vmcnt(0)
    v_mfma_f32_16x16x32_bf16 v[100:103], v[16:19], v[96:99], 0
    v_mfma_f32_16x16x32_bf16 v[104:107], v[20:23], v[96:99], 0
    v_mfma_f32_16x16x32_bf16 v[108:111], v[24:27], v[96:99], 0
    v_mfma_f32_16x16x32_bf16 v[112:115], v[28:31], v[96:99], 0
    v_mfma_f32_16x16x32_bf16 v[116:119], v[32:35], v[96:99], 0
    v_mfma_f32_16x16x32_bf16 v[120:123], v[36:39], v[96:99], 0
    v_mfma_f32_16x16x32_bf16 v[124:127], v[40:43], v[96:99], 0
    v_mfma_f32_16x16x32_bf16 v[128:131], v[44:47], v[96:99], 0
    s_lshl_b32 s6, s3, 8
    v_lshlrev_b32 v11, 4, v10
    v_lshl_add_u32 v11, v4, 6, v11
    v_lshl_add_u32 v11, v12, 2, v11
    v_add_u32 v11, s6, v11
    s_lshl_b32 s7, s3, 2
    v_lshlrev_b32 v12, 4, v10
    v_add_u32 v12, s7, v12
    v_mov_b32_dpp v132, v100 quad_perm:[0,1,2,3] row_mask:0xf bank_mask:0x1
    v_mov_b32_dpp v133, v104 quad_perm:[0,1,2,3] row_mask:0xf bank_mask:0x1
    v_mov_b32_dpp v132, v108 row_ror:4 row_mask:0xf bank_mask:0x2
    v_mov_b32_dpp v133, v112 row_ror:4 row_mask:0xf bank_mask:0x2
    v_mov_b32_dpp v132, v116 row_ror:8 row_mask:0xf bank_mask:0x4
    v_mov_b32_dpp v133, v120 row_ror:8 row_mask:0xf bank_mask:0x4
    v_mov_b32_dpp v132, v124 row_ror:12 row_mask:0xf bank_mask:0x8
    v_mov_b32_dpp v133, v128 row_ror:12 row_mask:0xf bank_mask:0x8
    v_add_f32_dpp v132, v101, v132 row_ror:12 row_mask:0xf bank_mask:0x1
    v_add_f32_dpp v133, v105, v133 row_ror:12 row_mask:0xf bank_mask:0x1
    v_add_f32_dpp v132, v109, v132 quad_perm:[0,1,2,3] row_mask:0xf bank_mask:0x2
    v_add_f32_dpp v133, v113, v133 quad_perm:[0,1,2,3] row_mask:0xf bank_mask:0x2
    v_add_f32_dpp v132, v117, v132 row_ror:4 row_mask:0xf bank_mask:0x4
    v_add_f32_dpp v133, v121, v133 row_ror:4 row_mask:0xf bank_mask:0x4
    v_add_f32_dpp v132, v125, v132 row_ror:8 row_mask:0xf bank_mask:0x8
    v_add_f32_dpp v133, v129, v133 row_ror:8 row_mask:0xf bank_mask:0x8
    v_add_f32_dpp v132, v102, v132 row_ror:8 row_mask:0xf bank_mask:0x1
    v_add_f32_dpp v133, v106, v133 row_ror:8 row_mask:0xf bank_mask:0x1
    v_add_f32_dpp v132, v110, v132 row_ror:12 row_mask:0xf bank_mask:0x2
    v_add_f32_dpp v133, v114, v133 row_ror:12 row_mask:0xf bank_mask:0x2
    v_add_f32_dpp v132, v118, v132 quad_perm:[0,1,2,3] row_mask:0xf bank_mask:0x4
    v_add_f32_dpp v133, v122, v133 quad_perm:[0,1,2,3] row_mask:0xf bank_mask:0x4
    v_add_f32_dpp v132, v126, v132 row_ror:4 row_mask:0xf bank_mask:0x8
    v_add_f32_dpp v133, v130, v133 row_ror:4 row_mask:0xf bank_mask:0x8
    v_add_f32_dpp v132, v103, v132 row_ror:4 row_mask:0xf bank_mask:0x1
    v_add_f32_dpp v133, v107, v133 row_ror:4 row_mask:0xf bank_mask:0x1
    v_add_f32_dpp v132, v111, v132 row_ror:8 row_mask:0xf bank_mask:0x2
    v_add_f32_dpp v133, v115, v133 row_ror:8 row_mask:0xf bank_mask:0x2
    v_add_f32_dpp v132, v119, v132 row_ror:12 row_mask:0xf bank_mask:0x4
    v_add_f32_dpp v133, v123, v133 row_ror:12 row_mask:0xf bank_mask:0x4
    v_add_f32_dpp v132, v127, v132 quad_perm:[0,1,2,3] row_mask:0xf bank_mask:0x8
    v_add_f32_dpp v133, v131, v133 quad_perm:[0,1,2,3] row_mask:0xf bank_mask:0x8
    v_cvt_pk_bf16_f32 v134, v132, v133
    v_lshlrev_b32 v132, 16, v134
    v_and_b32 v133, 0xffff0000, v134
    v_mul_f32 v132, 0x3db504f3, v132
    v_mul_f32 v133, 0x3db504f3, v133
    v_cvt_pk_bf16_f32 v134, v132, v133
    v_lshlrev_b32 v132, 16, v134
    v_and_b32 v133, 0xffff0000, v134
    v_max_f32 v135, v132, v133
    s_nop 1
    v_max_f32_dpp v135, v135, v135 row_ror:4 row_mask:0xf bank_mask:0xf
    s_nop 1
    v_max_f32_dpp v135, v135, v135 row_ror:8 row_mask:0xf bank_mask:0xf
    v_mov_b32 v136, v135
    s_nop 1
    v_permlane16_swap_b32 v135, v136
    s_nop 1
    v_max_f32 v135, v135, v136
    v_mov_b32 v136, v135
    s_nop 1
    v_permlane32_swap_b32 v135, v136
    s_nop 1
    v_max_f32 v135, v135, v136
    v_sub_f32 v132, v132, v135
    v_sub_f32 v133, v133, v135
    v_mul_f32 v132, 0x3fb8aa3b, v132
    v_mul_f32 v133, 0x3fb8aa3b, v133
    v_exp_f32 v132, v132
    v_exp_f32 v133, v133
    s_nop 0
    v_cvt_pk_bf16_f32 v134, v132, v133
    v_add_f32 v136, v132, v133
    ds_write_b32 v11, v134 offset:4096
    s_nop 1
    v_add_f32_dpp v136, v136, v136 row_ror:4 row_mask:0xf bank_mask:0xf
    s_nop 1
    v_add_f32_dpp v136, v136, v136 row_ror:8 row_mask:0xf bank_mask:0xf
    v_mov_b32 v137, v136
    s_nop 1
    v_permlane16_swap_b32 v136, v137
    s_nop 1
    v_add_f32 v136, v136, v137
    v_mov_b32 v137, v136
    s_nop 1
    v_permlane32_swap_b32 v136, v137
    s_nop 1
    v_add_f32 v136, v136, v137
    s_mov_b64 exec, 0xf
    ds_write_b32 v12, v135 offset:3840
    ds_write_b32 v12, v136 offset:3904
    s_mov_b64 exec, -1
    buffer_load_dwordx4 v[80:83], v7, s[28:31], 0 offen offset:0 nt
    buffer_load_dwordx4 v[84:87], v7, s[28:31], 0 offen offset:1024 nt
    buffer_load_dwordx4 v[88:91], v7, s[28:31], 0 offen offset:2048 nt
    buffer_load_dwordx4 v[92:95], v7, s[28:31], 0 offen offset:3072 nt
    v_lshrrev_b32 v12, 3, v2
    v_lshlrev_b32 v12, 9, v12
    v_and_b32 v13, 7, v2
    v_lshlrev_b32 v13, 4, v13
    v_add_u32 v12, v12, v13
    s_lshl_b32 s22, s4, 2
    s_lshr_b32 s7, s5, 3
    s_add_u32 s22, s22, s7
    s_lshl_b32 s22, s22, 15
    s_lshl_b32 s7, s3, 12
    s_add_u32 s20, s22, s7
    s_add_u32 s20, s20, 1048576
    s_add_u32 s21, s22, 1064960
    s_lshl_b32 s6, s4, 2
    s_add_u32 s6, s6, s3
    s_lshl_b32 s6, s6, 5
    s_add_u32 s6, s6, s5
    s_lshl_b32 s6, s6, 10
    s_add_u32 s26, s6, 4194304
    s_mov_b32 s99, 1
    s_lshl_b32 s6, s3, 10
    v_add_u32 v36, s6, v5
    s_barrier
    ds_read_b128 v[32:35], v36 offset:5120
    s_mov_b32 s24, 20000
    buffer_load_dwordx4 v[100:103], v12, s[8:11], s20 offen offset:0 sc1
    buffer_load_dwordx4 v[104:107], v12, s[8:11], s20 offen offset:128 sc1
    buffer_load_dwordx4 v[108:111], v12, s[8:11], s20 offen offset:256 sc1
    buffer_load_dwordx4 v[112:115], v12, s[8:11], s20 offen offset:384 sc1
    buffer_load_dwordx4 v[116:119], v13, s[8:11], s21 offen offset:0 sc1
    buffer_load_dwordx4 v[120:123], v13, s[8:11], s21 offen offset:128 sc1
    buffer_load_dwordx4 v[124:127], v13, s[8:11], s21 offen offset:256 sc1
    buffer_load_dwordx4 v[128:131], v13, s[8:11], s21 offen offset:384 sc1
    s_mov_b32 s6, 0x04000c0c
    s_mov_b32 s7, 0x0706000c
L_os_23:
    s_waitcnt vmcnt(0) lgkmcnt(0)
    v_xor_b32 v10, s12, v103
    v_xor_b32 v11, s12, v119
    v_or_b32 v10, v10, v11
    v_cmp_ne_u32 s[64:65], 0, v10
    v_xor_b32 v10, s12, v107
    v_xor_b32 v11, s12, v123
    v_or_b32 v10, v10, v11
    v_cmp_ne_u32 s[66:67], 0, v10
    v_xor_b32 v10, s12, v111
    v_xor_b32 v11, s12, v127
    v_or_b32 v10, v10, v11
    v_cmp_ne_u32 s[68:69], 0, v10
    v_xor_b32 v10, s12, v115
    v_xor_b32 v11, s12, v131
    v_or_b32 v10, v10, v11
    v_cmp_ne_u32 s[70:71], 0, v10
    s_nop 1
    s_or_b64 s[72:73], s[64:65], s[66:67]
    s_or_b64 s[74:75], s[68:69], s[70:71]
    s_or_b64 s[72:73], s[72:73], s[74:75]
    s_cbranch_scc0 L_osok_24
    s_mov_b64 exec, s[64:65]
    s_cbranch_execz L_osk_27
    buffer_load_dwordx4 v[100:103], v12, s[8:11], s20 offen offset:0 sc1
    buffer_load_dwordx4 v[116:119], v13, s[8:11], s21 offen offset:0 sc1
L_osk_27:
    s_mov_b64 exec, s[66:67]
    s_cbranch_execz L_osk_28
    buffer_load_dwordx4 v[104:107], v12, s[8:11], s20 offen offset:128 sc1
    buffer_load_dwordx4 v[120:123], v13, s[8:11], s21 offen offset:128 sc1
L_osk_28:
    s_mov_b64 exec, s[68:69]
    s_cbranch_execz L_osk_29
    buffer_load_dwordx4 v[108:111], v12, s[8:11], s20 offen offset:256 sc1
    buffer_load_dwordx4 v[124:127], v13, s[8:11], s21 offen offset:256 sc1
L_osk_29:
    s_mov_b64 exec, s[70:71]
    s_cbranch_execz L_osk_30
    buffer_load_dwordx4 v[112:115], v12, s[8:11], s20 offen offset:384 sc1
    buffer_load_dwordx4 v[128:131], v13, s[8:11], s21 offen offset:384 sc1
L_osk_30:
    s_mov_b64 exec, -1
    s_sub_u32 s24, s24, 1
    s_cmp_lg_u32 s24, 19984
    s_cbranch_scc1 L_os_23
    s_waitcnt vmcnt(0)
    s_branch L_osf_26
L_osok_24:
    v_max3_f32 v10, v116, v120, v124
    v_max_f32 v10, v10, v128
    v_perm_b32 v103, v102, v101, s6
    v_perm_b32 v103, v103, v100, s7
    v_max_f32_dpp v10, v10, v10 quad_perm:[1,0,3,2] row_mask:0xf bank_mask:0xf
    v_perm_b32 v107, v106, v105, s6
    v_perm_b32 v107, v107, v104, s7
    v_max_f32_dpp v10, v10, v10 quad_perm:[2,3,0,1] row_mask:0xf bank_mask:0xf
    v_perm_b32 v111, v110, v109, s6
    v_perm_b32 v111, v111, v108, s7
    v_max_f32_dpp v10, v10, v10 row_half_mirror row_mask:0xf bank_mask:0xf
    v_perm_b32 v115, v114, v113, s6
    v_perm_b32 v115, v115, v112, s7
    v_sub_f32 v116, v116, v10
    v_sub_f32 v120, v120, v10
    v_sub_f32 v124, v124, v10
    v_sub_f32 v128, v128, v10
    v_exp_f32 v116, v116
    v_exp_f32 v120, v120
    v_exp_f32 v124, v124
    v_exp_f32 v128, v128
    s_nop 0
    v_add_f32 v10, v116, v120
    v_add_f32 v11, v124, v128
    v_add_f32 v10, v10, v11
    v_mul_f32 v12, v116, v100
    v_mul_f32 v13, v116, v101
    v_mul_f32 v14, v116, v102
    v_mul_f32 v15, v116, v103
    v_fmac_f32 v12, v120, v104
    v_fmac_f32 v13, v120, v105
    v_fmac_f32 v14, v120, v106
    v_fmac_f32 v15, v120, v107
    v_fmac_f32 v12, v124, v108
    v_fmac_f32 v13, v124, v109
    v_fmac_f32 v14, v124, v110
    v_fmac_f32 v15, v124, v111
    v_fmac_f32 v12, v128, v112
    v_fmac_f32 v13, v128, v113
    v_fmac_f32 v14, v128, v114
    v_fmac_f32 v15, v128, v115
    v_add_f32_dpp v10, v10, v10 quad_perm:[1,0,3,2] row_mask:0xf bank_mask:0xf
    v_add_f32_dpp v12, v12, v12 quad_perm:[1,0,3,2] row_mask:0xf bank_mask:0xf
    v_add_f32_dpp v13, v13, v13 quad_perm:[1,0,3,2] row_mask:0xf bank_mask:0xf
    v_add_f32_dpp v14, v14, v14 quad_perm:[1,0,3,2] row_mask:0xf bank_mask:0xf
    v_add_f32_dpp v15, v15, v15 quad_perm:[1,0,3,2] row_mask:0xf bank_mask:0xf
    v_add_f32_dpp v10, v10, v10 quad_perm:[2,3,0,1] row_mask:0xf bank_mask:0xf
    v_add_f32_dpp v12, v12, v12 quad_perm:[2,3,0,1] row_mask:0xf bank_mask:0xf
    v_add_f32_dpp v13, v13, v13 quad_perm:[2,3,0,1] row_mask:0xf bank_mask:0xf
    v_add_f32_dpp v14, v14, v14 quad_perm:[2,3,0,1] row_mask:0xf bank_mask:0xf
    v_add_f32_dpp v15, v15, v15 quad_perm:[2,3,0,1] row_mask:0xf bank_mask:0xf
    v_add_f32_dpp v10, v10, v10 row_half_mirror row_mask:0xf bank_mask:0xf
    v_add_f32_dpp v12, v12, v12 row_half_mirror row_mask:0xf bank_mask:0xf
    v_add_f32_dpp v13, v13, v13 row_half_mirror row_mask:0xf bank_mask:0xf
    v_add_f32_dpp v14, v14, v14 row_half_mirror row_mask:0xf bank_mask:0xf
    v_add_f32_dpp v15, v15, v15 row_half_mirror row_mask:0xf bank_mask:0xf
    v_rcp_f32 v10, v10
    s_nop 0
    v_mul_f32 v12, v12, v10
    v_mul_f32 v13, v13, v10
    v_mul_f32 v14, v14, v10
    v_mul_f32 v15, v15, v10
    v_cvt_pk_bf16_f32 v240, v12, v13
    v_cvt_pk_bf16_f32 v241, v14, v15
L_c3:
    v_perm_b32 v100, v240, v240, v248
    v_perm_b32 v101, v240, v240, v250
    v_perm_b32 v102, v240, v240, v252
    v_perm_b32 v103, v240, v240, v254
    v_perm_b32 v104, v240, v240, v249
    v_perm_b32 v105, v240, v240, v251
    v_perm_b32 v106, v240, v240, v253
    v_perm_b32 v107, v240, v240, v255
    v_perm_b32 v108, v241, v241, v248
    v_perm_b32 v109, v241, v241, v250
    v_perm_b32 v110, v241, v241, v252
    v_perm_b32 v111, v241, v241, v254
    v_perm_b32 v112, v241, v241, v249
    v_perm_b32 v113, v241, v241, v251
    v_perm_b32 v114, v241, v241, v253
    v_perm_b32 v115, v241, v241, v255
    s_lshl_b32 s6, s3, 9
    v_lshrrev_b32 v10, 5, v2
    v_lshlrev_b32 v10, 8, v10
    v_and_b32 v11, 7, v2
    v_lshl_add_u32 v10, v11, 5, v10
    s_cmp_lg_u32 s3, 3
    s_cbranch_scc1 L_novote_32
    s_cmp_ge_u32 s2, 32
    s_cbranch_scc1 L_novote_32
    v_add_u32 v12, v117, v121
    v_add_u32 v13, v125, v129
    v_add_u32 v12, v12, v13
    s_nop 1
    v_add_u32_dpp v12, v12, v12 quad_perm:[1,0,3,2] row_mask:0xf bank_mask:0xf
    s_nop 1
    v_add_u32_dpp v12, v12, v12 quad_perm:[2,3,0,1] row_mask:0xf bank_mask:0xf
    s_nop 1
    v_add_u32_dpp v12, v12, v12 row_half_mirror row_mask:0xf bank_mask:0xf
    v_mov_b32 v13, 0
    ds_write_b32 v13, v12 offset:4008
L_novote_32:
    s_waitcnt vmcnt(0)
    v_mfma_f32_16x16x32_bf16 v[16:19], v[100:103], v[80:83], 0
    v_mfma_f32_16x16x32_bf16 v[16:19], v[104:107], v[84:87], v[16:19]
    v_mfma_f32_16x16x32_bf16 v[16:19], v[108:111], v[88:91], v[16:19]
    v_mfma_f32_16x16x32_bf16 v[16:19], v[112:115], v[92:95], v[16:19]
    v_and_b32 v11, 1, v4
    v_lshl_add_u32 v10, v11, 4, v10
    v_add_u32 v10, s6, v10
    s_mov_b32 exec_lo, 0x00ff00ff
    s_mov_b32 exec_hi, 0xff00ff00
    s_nop 2
    ds_write_b128 v10, v[16:19] offset:12288
    s_mov_b64 exec, -1
    s_cmp_lg_u32 s99, 1
    s_cbranch_scc1 L_nocp_33
    s_mov_b32 exec_hi, 1
    buffer_store_dwordx4 v[32:35], v5, s[8:11], s26 offen sc1
    s_mov_b32 exec_hi, -1
    s_mov_b32 s99, 0
L_nocp_33:
    s_waitcnt lgkmcnt(0)
    s_barrier
    s_cmp_eq_u32 s3, 5
    s_cbranch_scc1 L_red_34
    s_cmp_lg_u32 s3, 0
    s_cbranch_scc1 L_fin_35
    v_and_b32 v10, 3, v2
    v_lshlrev_b32 v10, 8, v10
    v_lshrrev_b32 v11, 2, v2
    v_lshl_add_u32 v10, v11, 4, v10
    ds_read_b128 v[16:19], v10 offset:12288
    ds_read_b128 v[20:23], v10 offset:13312
    ds_read_b128 v[24:27], v10 offset:14336
    s_and_b32 s6, s5, 7
    s_lshl_b32 s6, s6, 5
    s_lshl_b32 s7, s4, 2
    s_add_u32 s6, s6, s7
    s_lshr_b32 s7, s5, 3
    s_add_u32 s6, s6, s7
    s_lshl_b32 s6, s6, 8
    s_and_b32 s7, s6, 0x2000
    s_lshl_b32 s7, s7, 1
    s_sub_u32 s7, 0x12000, s7
    v_and_b32 v13, 1, v2
    s_add_u32 s6, s6, 2097152
    v_lshlrev_b32 v11, 4, v11
    v_mad_u32_u24 v11, v13, s7, v11
    s_lshr_b32 s20, s12, 8
    s_lshr_b32 s21, s12, 16
    s_lshr_b32 s22, s12, 24
    s_movk_i32 s23, 0xff
    v_mov_b32 v12, s23
    s_waitcnt lgkmcnt(0)
    v_add_f32 v16, v16, v20
    v_add_f32 v17, v17, v21
    v_add_f32 v18, v18, v22
    v_add_f32 v19, v19, v23
    v_add_f32 v16, v16, v24
    v_add_f32 v17, v17, v25
    v_add_f32 v18, v18, v26
    v_add_f32 v19, v19, v27
    s_nop 0
    v_add_f32_dpp v16, v16, v16 quad_perm:[1,0,3,2] row_mask:0xf bank_mask:0xf
    v_add_f32_dpp v17, v17, v17 quad_perm:[1,0,3,2] row_mask:0xf bank_mask:0xf
    v_add_f32_dpp v18, v18, v18 quad_perm:[1,0,3,2] row_mask:0xf bank_mask:0xf
    v_add_f32_dpp v19, v19, v19 quad_perm:[1,0,3,2] row_mask:0xf bank_mask:0xf
    v_add_f32_dpp v16, v16, v16 quad_perm:[2,3,0,1] row_mask:0xf bank_mask:0xf
    v_add_f32_dpp v17, v17, v17 quad_perm:[2,3,0,1] row_mask:0xf bank_mask:0xf
    v_add_f32_dpp v18, v18, v18 quad_perm:[2,3,0,1] row_mask:0xf bank_mask:0xf
    v_add_f32_dpp v19, v19, v19 quad_perm:[2,3,0,1] row_mask:0xf bank_mask:0xf
    v_bfi_b32 v16, v12, s12, v16
    v_bfi_b32 v17, v12, s20, v17
    v_bfi_b32 v18, v12, s21, v18
    v_bfi_b32 v19, v12, s22, v19
    s_mov_b32 exec_lo, 0x33333333
    s_mov_b32 exec_hi, 0x33333333
    buffer_store_dwordx4 v[16:19], v11, s[8:11], s6 offen sc1
    s_branch L_fin_35
L_red_34:
    s_cmp_ge_u32 s2, 32
    s_cbranch_scc1 L_fin_35
    s_mov_b32 s52, s16
    s_mov_b32 s53, s17
    s_mov_b32 s54, 1024
    s_mov_b32 s55, 0x20000
    v_and_b32 v10, 3, v2
    v_lshlrev_b32 v11, 3, v10
    s_lshl_b32 s7, s2, 5
    v_add_u32 v11, s7, v11
    buffer_load_dwordx2 v[24:25], v11, s[52:55], 0 offen
    v_lshrrev_b32 v12, 2, v2
    v_lshlrev_b32 v12, 8, v12
    v_lshl_add_u32 v12, v10, 4, v12
    s_lshr_b32 s6, s2, 2
    s_lshl_b32 s6, s6, 13
    s_and_b32 s7, s2, 3
    s_lshl_b32 s7, s7, 6
    s_add_u32 s6, s6, s7
    v_mov_b32 v13, 0
    ds_read_b32 v14, v13 offset:4008
    s_and_b32 s7, s6, 0x2000
    s_lshl_b32 s21, s7, 1
    s_sub_u32 s21, 0x12000, s21
    s_waitcnt lgkmcnt(0)
    v_readfirstlane_b32 s20, v14
    s_cmp_lt_i32 s20, 0
    s_cselect_b32 s20, 0x2000, 0
    s_cmp_eq_u32 s7, s20
    s_cselect_b32 s7, 0, s21
    s_add_u32 s6, s6, s7
    s_add_u32 s6, s6, 2097152
    s_add_u32 s7, s6, 4096
    s_mov_b32 s20, 0x0c0c0400
    s_mov_b32 s21, 0x04000c0c
    s_mov_b32 s24, 20000
    buffer_load_dwordx4 v[16:19], v12, s[8:11], s6 offen sc1
    buffer_load_dwordx4 v[20:23], v12, s[8:11], s7 offen sc1
L_fp_36:
    s_waitcnt vmcnt(0)
    v_perm_b32 v13, v17, v16, s20
    v_perm_b32 v14, v19, v18, s21
    v_perm_b32 v15, v21, v20, s20
    v_perm_b32 v26, v23, v22, s21
    v_or_b32 v13, v13, v14
    v_or_b32 v15, v15, v26
    v_cmp_ne_u32 s[64:65], s12, v13
    v_cmp_ne_u32 s[66:67], s12, v15
    s_nop 1
    s_or_b64 s[68:69], s[64:65], s[66:67]
    s_cbranch_scc0 L_fpok_37
    s_mov_b64 exec, s[64:65]
    s_cbranch_execz L_fpa_38
    buffer_load_dwordx4 v[16:19], v12, s[8:11], s6 offen sc1
L_fpa_38:
    s_mov_b64 exec, s[66:67]
    s_cbranch_execz L_fpb_39
    buffer_load_dwordx4 v[20:23], v12, s[8:11], s7 offen sc1
L_fpb_39:
    s_mov_b64 exec, -1
    s_sub_u32 s24, s24, 1
    s_cmp_lg_u32 s24, 0
    s_cbranch_scc1 L_fp_36
    s_waitcnt vmcnt(0)
L_fpok_37:
    v_add_f32 v16, v16, v20
    v_add_f32 v17, v17, v21
    v_add_f32 v18, v18, v22
    v_add_f32 v19, v19, v23
    s_nop 0
    v_add_f32_dpp v16, v16, v16 row_ror:4 row_mask:0xf bank_mask:0xf
    v_add_f32_dpp v17, v17, v17 row_ror:4 row_mask:0xf bank_mask:0xf
    v_add_f32_dpp v18, v18, v18 row_ror:4 row_mask:0xf bank_mask:0xf
    v_add_f32_dpp v19, v19, v19 row_ror:4 row_mask:0xf bank_mask:0xf
    v_add_f32_dpp v16, v16, v16 row_ror:8 row_mask:0xf bank_mask:0xf
    v_add_f32_dpp v17, v17, v17 row_ror:8 row_mask:0xf bank_mask:0xf
    v_add_f32_dpp v18, v18, v18 row_ror:8 row_mask:0xf bank_mask:0xf
    v_add_f32_dpp v19, v19, v19 row_ror:8 row_mask:0xf bank_mask:0xf
    v_mov_b32 v20, v16
    v_mov_b32 v21, v17
    v_mov_b32 v22, v18
    v_mov_b32 v23, v19
    s_nop 1
    v_permlane16_swap_b32 v16, v20
    v_permlane16_swap_b32 v17, v21
    v_permlane16_swap_b32 v18, v22
    v_permlane16_swap_b32 v19, v23
    s_nop 1
    v_add_f32 v16, v16, v20
    v_add_f32 v17, v17, v21
    v_add_f32 v18, v18, v22
    v_add_f32 v19, v19, v23
    v_mov_b32 v20, v16
    v_mov_b32 v21, v17
    v_mov_b32 v22, v18
    v_mov_b32 v23, v19
    s_nop 1
    v_permlane32_swap_b32 v16, v20
    v_permlane32_swap_b32 v17, v21
    v_permlane32_swap_b32 v18, v22
    v_permlane32_swap_b32 v19, v23
    s_nop 1
    v_add_f32 v16, v16, v20
    v_add_f32 v17, v17, v21
    v_add_f32 v18, v18, v22
    v_add_f32 v19, v19, v23
    v_lshlrev_b32 v20, 16, v24
    v_and_b32 v21, 0xffff0000, v24
    v_lshlrev_b32 v22, 16, v25
    v_and_b32 v23, 0xffff0000, v25
    v_add_f32 v16, v16, v20
    v_add_f32 v17, v17, v21
    v_add_f32 v18, v18, v22
    v_add_f32 v19, v19, v23
    v_cvt_pk_bf16_f32 v16, v16, v17
    v_cvt_pk_bf16_f32 v17, v18, v19
    s_mov_b32 s52, s18
    s_mov_b32 s53, s19
    s_mov_b64 exec, 0xf
    buffer_store_dwordx2 v[16:17], v11, s[52:55], 0 offen
    s_cmp_lg_u32 s2, 0
    s_cbranch_scc1 L_ep_40
    s_mov_b64 exec, 1
    v_mov_b32 v12, 0
    v_mov_b32 v13, s12
    buffer_store_dword v13, v12, s[8:11], 0 offen sc1
L_ep_40:
L_fin_35:
L_finx:
L_end:
    s_endpgm
L_slow:
    s_cmp_eq_u32 s64, 1
    s_cbranch_scc1 L_uf
    s_lshl_b32 s15, s5, 2
    s_add_u32 s15, s15, s3
    s_lshl_b32 s15, s15, 13
    s_lshl_b32 s7, s4, 24
    s_add_u32 s15, s15, s7
    s_add_u32 s15, s15, 15728640
    v_lshrrev_b32 v6, 2, v3
    v_lshlrev_b32 v6, 8, v6
    v_and_b32 v8, 3, v3
    v_lshl_add_u32 v6, v8, 6, v6
    v_lshl_add_u32 v6, v4, 4, v6
    s_movk_i32 s42, 8192
    s_mov_b32 s43, 0x20000
    s_waitcnt lgkmcnt(0)
    s_add_u32 s40, s18, s15
    s_addc_u32 s41, s19, 0
L_a1:
    v_mov_b32 v8, 0
    v_lshlrev_b32 v9, 2, v3
    ds_write_b32 v9, v8 offset:3904
    s_lshr_b32 s15, s5, 3
    s_lshl_b32 s7, s4, 2
    s_add_u32 s7, s7, s15
    s_lshl_b32 s7, s7, 2
    s_add_u32 s7, s7, s3
    s_lshl_b32 s7, s7, 15
    s_and_b32 s15, s5, 7
    s_lshl_b32 s15, s15, 7
    s_add_u32 s7, s7, s15
    s_add_u32 s28, s24, s7
    s_addc_u32 s29, s25, 0
    s_mov_b32 s30, 31872
    s_mov_b32 s31, 0x20000
    s_load_dword s12, s[38:39], 0
    s_mov_b32 s8, s38
    s_mov_b32 s9, s39
    s_mov_b32 s10, 16777216
    s_mov_b32 s11, 0x20000
    v_lshrrev_b32 v7, 3, v2
    v_lshlrev_b32 v7, 12, v7
    v_and_b32 v8, 7, v2
    v_lshl_add_u32 v7, v8, 4, v7
    s_mov_b32 s60, 4096
    s_barrier
    s_cmp_ge_u32 s5, 16
    s_cbranch_scc1 L_a2
    buffer_load_dwordx4 v[16:19], v6, s[40:43], 0 offen offset:0 nt
    buffer_load_dwordx4 v[20:23], v6, s[40:43], 0 offen offset:1024 nt
    buffer_load_dwordx4 v[24:27], v6, s[40:43], 0 offen offset:2048 nt
    buffer_load_dwordx4 v[28:31], v6, s[40:43], 0 offen offset:3072 nt
    buffer_load_dwordx4 v[32:35], v6, s[40:43], s60 offen offset:0 nt
    buffer_load_dwordx4 v[36:39], v6, s[40:43], s60 offen offset:1024 nt
    buffer_load_dwordx4 v[40:43], v6, s[40:43], s60 offen offset:2048 nt
    buffer_load_dwordx4 v[44:47], v6, s[40:43], s60 offen offset:3072 nt
L_a2:
    v_and_b32 v11, 1, v2
    v_bfe_u32 v12, v2, 1, 2
    v_cmp_eq_u32 vcc, 1, v11
    v_mov_b32 v13, 0x0c0c0100
    v_mov_b32 v14, 0x01000c0c
    v_cndmask_b32 v13, v13, v14, vcc
    v_mov_b32 v14, 0x0c0c0302
    v_mov_b32 v15, 0x03020c0c
    v_cndmask_b32 v14, v14, v15, vcc
    v_mov_b32 v15, 0x0c0c0c0c
    v_cmp_eq_u32 vcc, 0, v12
    s_nop 1
    v_cndmask_b32 v248, v15, v13, vcc
    v_cndmask_b32 v249, v15, v14, vcc
    v_cmp_eq_u32 vcc, 1, v12
    s_nop 1
    v_cndmask_b32 v250, v15, v13, vcc
    v_cndmask_b32 v251, v15, v14, vcc
    v_cmp_eq_u32 vcc, 2, v12
    s_nop 1
    v_cndmask_b32 v252, v15, v13, vcc
    v_cndmask_b32 v253, v15, v14, vcc
    v_cmp_eq_u32 vcc, 3, v12
    s_nop 1
    v_cndmask_b32 v254, v15, v13, vcc
    v_cndmask_b32 v255, v15, v14, vcc
    s_waitcnt lgkmcnt(0)
    s_add_u32 s12, s12, 2654435769
    s_barrier
    s_mov_b32 s98, s3
    s_branch L_c1
L_uf:
    s_setprio 3
    s_lshl_b32 s7, s4, 2
    s_mul_i32 s6, s4, 3
    s_add_u32 s6, s6, 4
    s_cmp_lt_u32 s4, 4
    s_cselect_b32 s57, s7, s6
    s_cselect_b32 s58, 4, 3
    s_sub_u32 s7, s5, 16
    s_lshr_b32 s15, s7, 2
    s_sub_u32 s65, s3, 4
    s_and_b32 s71, s5, 15
    s_lshl_b32 s66, s58, 2
    s_add_u32 s66, s66, 16
    s_cmp_lt_u32 s5, s66
    s_cselect_b32 s64, 1, 0
    s_add_u32 s66, s57, s15
    s_lshl_b32 s66, s66, 7
    s_and_b32 s6, s7, 1
    s_lshl_b32 s6, s6, 6
    s_add_u32 s6, s66, s6
    s_movk_i32 s67, 3584
    s_mul_i32 s66, s67, s65
    s_lshl_b32 s66, s66, 8
    s_add_u32 s6, s6, s66
    s_cmp_eq_u32 s64, 1
    s_cselect_b32 s6, s6, 0
    s_cselect_b32 s42, 913984, 0
    s_mov_b32 s43, 0x20000
    v_lshrrev_b32 v6, 2, v2
    v_mul_u32_u24 v6, 57344, v6
    v_and_b32 v12, 3, v2
    v_lshl_add_u32 v6, v12, 4, v6
    v_mov_b32 v8, 0
    v_mov_b32 v9, 0
    ds_write_b32 v8, v8 offset:3968
    ds_write_b64 v8, v[8:9] offset:3976
    s_lshl_b32 s72, s7, 1
    s_add_u32 s72, s72, s65
    s_lshl_b32 s72, s72, 17
    s_lshl_b32 s73, s4, 10
    s_add_u32 s72, s72, s73
    s_mov_b32 s78, 131072
    s_mov_b32 s79, 0x20000
    s_mov_b32 s74, 32768
    s_waitcnt lgkmcnt(0)
    global_load_dwordx4 v[88:91], v5, s[16:17]
    s_add_u32 s76, s22, s72
    s_addc_u32 s77, s23, 0
    v_lshlrev_b32 v12, 13, v2
    s_mov_b64 exec, 0xfff
    buffer_load_dword v93, v12, s[76:79], s74 offen offset:384
    s_add_u32 s74, s74, 512
    s_cmp_eq_u32 s4, 7
    s_cselect_b64 exec, 0xfff, 0
    buffer_load_dword v92, v12, s[76:79], s74 offen offset:384
    s_mov_b64 exec, -1
    s_load_dword s12, s[38:39], 0
    s_mov_b32 s8, s38
    s_mov_b32 s9, s39
    s_mov_b32 s10, 16777216
    s_mov_b32 s11, 0x20000
    s_bitcmp1_b32 s7, 1
    s_cselect_b32 s40, s30, s28
    s_cselect_b32 s41, s31, s29
    s_add_u32 s40, s40, s6
    s_addc_u32 s41, s41, 0
    s_barrier
    s_mov_b32 s6, 0
    buffer_load_dwordx4 v[16:19], v6, s[40:43], s6 offen nt
    s_add_u32 s6, s6, s67
    buffer_load_dwordx4 v[20:23], v6, s[40:43], s6 offen nt
    s_add_u32 s6, s6, s67
    buffer_load_dwordx4 v[24:27], v6, s[40:43], s6 offen nt
    s_add_u32 s6, s6, s67
    buffer_load_dwordx4 v[28:31], v6, s[40:43], s6 offen nt
    s_add_u32 s6, s6, s67
    buffer_load_dwordx4 v[32:35], v6, s[40:43], s6 offen nt
    s_add_u32 s6, s6, s67
    buffer_load_dwordx4 v[36:39], v6, s[40:43], s6 offen nt
    s_add_u32 s6, s6, s67
    buffer_load_dwordx4 v[40:43], v6, s[40:43], s6 offen nt
    s_add_u32 s6, s6, s67
    buffer_load_dwordx4 v[44:47], v6, s[40:43], s6 offen nt
    s_add_u32 s6, s6, s67
    buffer_load_dwordx4 v[48:51], v6, s[40:43], s6 offen nt
    s_add_u32 s6, s6, s67
    buffer_load_dwordx4 v[52:55], v6, s[40:43], s6 offen nt
    s_add_u32 s6, s6, s67
    buffer_load_dwordx4 v[56:59], v6, s[40:43], s6 offen nt
    s_add_u32 s6, s6, s67
    buffer_load_dwordx4 v[60:63], v6, s[40:43], s6 offen nt
    s_add_u32 s6, s6, s67
    buffer_load_dwordx4 v[64:67], v6, s[40:43], s6 offen nt
    s_add_u32 s6, s6, s67
    buffer_load_dwordx4 v[68:71], v6, s[40:43], s6 offen nt
    s_add_u32 s6, s6, s67
    buffer_load_dwordx4 v[72:75], v6, s[40:43], s6 offen nt
    s_add_u32 s6, s6, s67
    buffer_load_dwordx4 v[76:79], v6, s[40:43], s6 offen nt
    s_branch L_u2
L_pvw:
    s_sub_u32 s14, s3, 6
    s_lshl_b32 s68, s4, 24
    s_lshl_b32 s69, s5, 15
    s_add_u32 s68, s68, s69
    s_lshl_b32 s69, s14, 7
    s_add_u32 s68, s68, s69
    s_add_u32 s68, s68, 15728640
    v_and_b32 v10, 3, v2
    s_waitcnt lgkmcnt(0)
    s_add_u32 s44, s20, s68
    s_addc_u32 s45, s21, 0
    s_mov_b32 s46, 32640
    s_mov_b32 s47, 0x20000
    s_load_dword s12, s[38:39], 0
    s_mov_b32 s8, s38
    s_mov_b32 s9, s39
    s_mov_b32 s10, 16777216
    s_mov_b32 s11, 0x20000
    s_lshl_b32 s6, s2, 1
    s_add_u32 s6, s6, s14
    s_and_b32 s7, s6, 31
    s_lshl_b32 s7, s7, 7
    s_lshr_b32 s6, s6, 5
    s_and_b32 s72, s6, 1
    s_lshl_b32 s72, s72, 12
    s_add_u32 s7, s7, s72
    s_lshr_b32 s6, s6, 1
    s_lshl_b32 s6, s6, 14
    s_add_u32 s6, s6, s7
    s_add_u32 s6, s6, 2228224
    s_add_u32 s7, s6, 0x2000
    s_add_u32 s72, s8, s6
    s_addc_u32 s73, s9, 0
    s_add_u32 s74, s8, s7
    s_addc_u32 s75, s9, 0
    s_load_dword s68, s[72:73], 0 glc
    s_load_dword s69, s[74:75], 0 glc
    s_barrier
    s_waitcnt lgkmcnt(0)
    s_add_u32 s12, s12, 2654435769
    s_xor_b32 s70, s12, 0x5bd1e995
    s_mov_b32 s71, 0
    s_waitcnt lgkmcnt(0)
    s_mov_b32 s68, s70
    s_mov_b32 s69, s70
    s_bitcmp1_b32 s14, 0
    s_cbranch_scc1 L_tr_12
    s_load_dword s68, s[72:73], 0 glc
    s_load_dword s69, s[74:75], 0 glc
    s_branch L_tr_13
L_tr_12:
    s_load_dword s69, s[74:75], 0 glc
    s_load_dword s68, s[72:73], 0 glc
L_tr_13:
    s_waitcnt lgkmcnt(1)
    s_cmp_lg_u32 s68, s70
    s_cselect_b32 s66, 1, 0
    s_cmp_lg_u32 s69, s70
    s_cselect_b32 s67, 1, 0
    s_sub_i32 s66, s66, s67
    s_add_i32 s71, s71, s66
    s_waitcnt lgkmcnt(0)
L_trs_11:
    s_lshl_b32 s6, s14, 2
    v_mov_b32 v12, s6
    v_mov_b32 v13, s71
    ds_write_b32 v12, v13 offset:4000
    s_waitcnt lgkmcnt(0)
    s_barrier
    v_mov_b32 v12, 0
    ds_read_b64 v[98:99], v12 offset:4000
    v_lshlrev_b32 v8, 8, v4
    v_lshl_add_u32 v8, v3, 3, v8
    s_mov_b32 s6, 0
    buffer_load_dwordx2 v[140:141], v8, s[44:47], s6 offen offset:0 nt
    buffer_load_dwordx2 v[142:143], v8, s[44:47], s6 offen offset:1024 nt
    buffer_load_dwordx2 v[144:145], v8, s[44:47], s6 offen offset:2048 nt
    buffer_load_dwordx2 v[146:147], v8, s[44:47], s6 offen offset:3072 nt
    s_add_u32 s6, s6, 4096
    buffer_load_dwordx2 v[148:149], v8, s[44:47], s6 offen offset:0 nt
    buffer_load_dwordx2 v[150:151], v8, s[44:47], s6 offen offset:1024 nt
    buffer_load_dwordx2 v[152:153], v8, s[44:47], s6 offen offset:2048 nt
    buffer_load_dwordx2 v[154:155], v8, s[44:47], s6 offen offset:3072 nt
    s_add_u32 s6, s6, 4096
    buffer_load_dwordx2 v[156:157], v8, s[44:47], s6 offen offset:0 nt
    buffer_load_dwordx2 v[158:159], v8, s[44:47], s6 offen offset:1024 nt
    buffer_load_dwordx2 v[160:161], v8, s[44:47], s6 offen offset:2048 nt
    buffer_load_dwordx2 v[162:163], v8, s[44:47], s6 offen offset:3072 nt
    s_add_u32 s6, s6, 4096
    buffer_load_dwordx2 v[164:165], v8, s[44:47], s6 offen offset:0 nt
    buffer_load_dwordx2 v[166:167], v8, s[44:47], s6 offen offset:1024 nt
    buffer_load_dwordx2 v[168:169], v8, s[44:47], s6 offen offset:2048 nt
    buffer_load_dwordx2 v[170:171], v8, s[44:47], s6 offen offset:3072 nt
    s_add_u32 s6, s6, 4096
    buffer_load_dwordx2 v[172:173], v8, s[44:47], s6 offen offset:0 nt
    buffer_load_dwordx2 v[174:175], v8, s[44:47], s6 offen offset:1024 nt
    buffer_load_dwordx2 v[176:177], v8, s[44:47], s6 offen offset:2048 nt
    buffer_load_dwordx2 v[178:179], v8, s[44:47], s6 offen offset:3072 nt
    s_add_u32 s6, s6, 4096
    buffer_load_dwordx2 v[180:181], v8, s[44:47], s6 offen offset:0 nt
    buffer_load_dwordx2 v[182:183], v8, s[44:47], s6 offen offset:1024 nt
    buffer_load_dwordx2 v[184:185], v8, s[44:47], s6 offen offset:2048 nt
    buffer_load_dwordx2 v[186:187], v8, s[44:47], s6 offen offset:3072 nt
    s_add_u32 s6, s6, 4096
    buffer_load_dwordx2 v[188:189], v8, s[44:47], s6 offen offset:0 nt
    buffer_load_dwordx2 v[190:191], v8, s[44:47], s6 offen offset:1024 nt
    buffer_load_dwordx2 v[192:193], v8, s[44:47], s6 offen offset:2048 nt
    buffer_load_dwordx2 v[194:195], v8, s[44:47], s6 offen offset:3072 nt
    s_add_u32 s6, s6, 4096
    buffer_load_dwordx2 v[196:197], v8, s[44:47], s6 offen offset:0 nt
    buffer_load_dwordx2 v[198:199], v8, s[44:47], s6 offen offset:1024 nt
    buffer_load_dwordx2 v[200:201], v8, s[44:47], s6 offen offset:2048 nt
    buffer_load_dwordx2 v[202:203], v8, s[44:47], s6 offen offset:3072 nt
    v_lshlrev_b32 v9, 4, v10
    v_lshl_add_u32 v8, v4, 6, v9
    v_lshlrev_b32 v11, 15, v10
    v_lshl_add_u32 v139, v4, 11, v11
    s_lshl_b32 s6, s14, 8
    v_lshlrev_b32 v138, 10, v10
    v_lshl_add_u32 v138, v4, 6, v138
    v_add_u32 v138, s6, v138
    s_lshl_b32 s6, s4, 17
    s_lshl_b32 s7, s14, 13
    s_add_u32 s7, s7, s6
    s_lshl_b32 s20, s5, 4
    s_add_u32 s7, s7, s20
    s_add_u32 s13, s7, 1048576
    s_add_u32 s7, s13, 16384
    s_mov_b32 s20, 0x07060501
    s_mov_b32 s21, 0x07060502
    s_mov_b32 s22, 0x07060503
    s_mov_b32 s70, 0x05040100
    s_mov_b32 s71, 0x07060302
    v_mov_b32 v227, s12
    v_mov_b32 v231, s12
    v_mov_b32 v235, s12
    v_mov_b32 v239, s12
    v_mov_b32 v223, s12
    s_waitcnt vmcnt(24)
    v_perm_b32 v16, v142, v140, s70
    v_perm_b32 v20, v142, v140, s71
    v_perm_b32 v24, v143, v141, s70
    v_perm_b32 v28, v143, v141, s71
    v_perm_b32 v17, v146, v144, s70
    v_perm_b32 v21, v146, v144, s71
    v_perm_b32 v25, v147, v145, s70
    v_perm_b32 v29, v147, v145, s71
    v_perm_b32 v18, v150, v148, s70
    v_perm_b32 v22, v150, v148, s71
    v_perm_b32 v26, v151, v149, s70
    v_perm_b32 v30, v151, v149, s71
    v_perm_b32 v19, v154, v152, s70
    v_perm_b32 v23, v154, v152, s71
    v_perm_b32 v27, v155, v153, s70
    v_perm_b32 v31, v155, v153, s71
    s_waitcnt vmcnt(16)
    v_perm_b32 v32, v158, v156, s70
    v_perm_b32 v36, v158, v156, s71
    v_perm_b32 v40, v159, v157, s70
    v_perm_b32 v44, v159, v157, s71
    v_perm_b32 v33, v162, v160, s70
    v_perm_b32 v37, v162, v160, s71
    v_perm_b32 v41, v163, v161, s70
    v_perm_b32 v45, v163, v161, s71
    v_perm_b32 v34, v166, v164, s70
    v_perm_b32 v38, v166, v164, s71
    v_perm_b32 v42, v167, v165, s70
    v_perm_b32 v46, v167, v165, s71
    v_perm_b32 v35, v170, v168, s70
    v_perm_b32 v39, v170, v168, s71
    v_perm_b32 v43, v171, v169, s70
    v_perm_b32 v47, v171, v169, s71
    s_waitcnt vmcnt(8)
    v_perm_b32 v48, v174, v172, s70
    v_perm_b32 v52, v174, v172, s71
    v_perm_b32 v56, v175, v173, s70
    v_perm_b32 v60, v175, v173, s71
    v_perm_b32 v49, v178, v176, s70
    v_perm_b32 v53, v178, v176, s71
    v_perm_b32 v57, v179, v177, s70
    v_perm_b32 v61, v179, v177, s71
    v_perm_b32 v50, v182, v180, s70
    v_perm_b32 v54, v182, v180, s71
    v_perm_b32 v58, v183, v181, s70
    v_perm_b32 v62, v183, v181, s71
    v_perm_b32 v51, v186, v184, s70
    v_perm_b32 v55, v186, v184, s71
    v_perm_b32 v59, v187, v185, s70
    v_perm_b32 v63, v187, v185, s71
    s_mov_b32 s24, 20000
L_pf_14:
    ds_read_b128 v[104:107], v9 offset:3904
    ds_read_b128 v[204:207], v8 offset:4096
    ds_read_b128 v[208:211], v8 offset:4352
    ds_read_b128 v[100:103], v9 offset:3840
    ds_read_b128 v[212:215], v8 offset:4608
    ds_read_b128 v[216:219], v8 offset:4864
    s_waitcnt lgkmcnt(4)
    v_mfma_f32_16x16x32_bf16 v[140:143], v[16:19], v[204:207], 0
    v_mfma_f32_16x16x32_bf16 v[144:147], v[20:23], v[204:207], 0
    v_mfma_f32_16x16x32_bf16 v[148:151], v[24:27], v[204:207], 0
    v_mfma_f32_16x16x32_bf16 v[152:155], v[28:31], v[204:207], 0
    v_min3_u32 v108, v104, v105, v106
    v_min_u32 v108, v108, v107
    v_cmp_eq_u32 vcc, 0, v108
    s_waitcnt lgkmcnt(3)
    v_mfma_f32_16x16x32_bf16 v[156:159], v[32:35], v[208:211], 0
    v_mfma_f32_16x16x32_bf16 v[160:163], v[36:39], v[208:211], 0
    v_mfma_f32_16x16x32_bf16 v[164:167], v[40:43], v[208:211], 0
    v_mfma_f32_16x16x32_bf16 v[168:171], v[44:47], v[208:211], 0
    s_cmp_eq_u64 vcc, 0
    s_cbranch_scc1 L_pfok_15
    s_waitcnt lgkmcnt(0)
    s_sub_u32 s24, s24, 1
    s_cmp_lg_u32 s24, 0
    s_cbranch_scc1 L_pf_14
L_pfok_15:
    s_waitcnt lgkmcnt(1)
    v_mfma_f32_16x16x32_bf16 v[172:175], v[48:51], v[212:215], 0
    v_mfma_f32_16x16x32_bf16 v[176:179], v[52:55], v[212:215], 0
    v_mfma_f32_16x16x32_bf16 v[180:183], v[56:59], v[212:215], 0
    v_mfma_f32_16x16x32_bf16 v[184:187], v[60:63], v[212:215], 0
    v_max3_f32 v108, v100, v101, v102
    v_max_f32 v108, v108, v103
    v_sub_f32 v100, v100, v108
    v_sub_f32 v101, v101, v108
    v_sub_f32 v102, v102, v108
    v_sub_f32 v103, v103, v108
    v_mul_f32 v100, 0x3fb8aa3b, v100
    v_mul_f32 v101, 0x3fb8aa3b, v101
    v_mul_f32 v102, 0x3fb8aa3b, v102
    v_mul_f32 v103, 0x3fb8aa3b, v103
    v_exp_f32 v100, v100
    v_exp_f32 v101, v101
    v_exp_f32 v102, v102
    v_exp_f32 v103, v103
    v_mul_f32 v108, 0x3fb8aa3b, v108
    v_mul_f32 v109, v100, v104
    v_fmac_f32 v109, v101, v105
    v_fmac_f32 v109, v102, v106
    v_fmac_f32 v109, v103, v107
    v_rcp_f32 v110, v109
    v_log_f32 v111, v109
    s_nop 0
    v_mul_f32 v112, v100, v110
    v_mul_f32 v113, v101, v110
    v_mul_f32 v114, v102, v110
    v_mul_f32 v115, v103, v110
    v_add_f32 v220, v108, v111
    v_add_u32 v221, v98, v99
    v_mov_b32 v222, 0
    v_pk_mul_f32 v[140:141], v[140:141], v[112:113] op_sel:[0,0] op_sel_hi:[1,0]
    v_pk_mul_f32 v[142:143], v[142:143], v[112:113] op_sel:[0,0] op_sel_hi:[1,0]
    v_pk_mul_f32 v[144:145], v[144:145], v[112:113] op_sel:[0,0] op_sel_hi:[1,0]
    v_pk_mul_f32 v[146:147], v[146:147], v[112:113] op_sel:[0,0] op_sel_hi:[1,0]
    v_pk_mul_f32 v[148:149], v[148:149], v[112:113] op_sel:[0,0] op_sel_hi:[1,0]
    v_pk_mul_f32 v[150:151], v[150:151], v[112:113] op_sel:[0,0] op_sel_hi:[1,0]
    v_pk_mul_f32 v[152:153], v[152:153], v[112:113] op_sel:[0,0] op_sel_hi:[1,0]
    v_pk_mul_f32 v[154:155], v[154:155], v[112:113] op_sel:[0,0] op_sel_hi:[1,0]
    v_pk_fma_f32 v[140:141], v[156:157], v[112:113], v[140:141] op_sel:[0,1,0] op_sel_hi:[1,1,1]
    v_pk_fma_f32 v[142:143], v[158:159], v[112:113], v[142:143] op_sel:[0,1,0] op_sel_hi:[1,1,1]
    v_pk_fma_f32 v[144:145], v[160:161], v[112:113], v[144:145] op_sel:[0,1,0] op_sel_hi:[1,1,1]
    v_pk_fma_f32 v[146:147], v[162:163], v[112:113], v[146:147] op_sel:[0,1,0] op_sel_hi:[1,1,1]
    v_pk_fma_f32 v[148:149], v[164:165], v[112:113], v[148:149] op_sel:[0,1,0] op_sel_hi:[1,1,1]
    v_pk_fma_f32 v[150:151], v[166:167], v[112:113], v[150:151] op_sel:[0,1,0] op_sel_hi:[1,1,1]
    v_pk_fma_f32 v[152:153], v[168:169], v[112:113], v[152:153] op_sel:[0,1,0] op_sel_hi:[1,1,1]
    v_pk_fma_f32 v[154:155], v[170:171], v[112:113], v[154:155] op_sel:[0,1,0] op_sel_hi:[1,1,1]
    s_waitcnt lgkmcnt(0)
    v_pk_fma_f32 v[140:141], v[172:173], v[114:115], v[140:141] op_sel:[0,0,0] op_sel_hi:[1,0,1]
    v_pk_fma_f32 v[142:143], v[174:175], v[114:115], v[142:143] op_sel:[0,0,0] op_sel_hi:[1,0,1]
    v_pk_fma_f32 v[144:145], v[176:177], v[114:115], v[144:145] op_sel:[0,0,0] op_sel_hi:[1,0,1]
    v_pk_fma_f32 v[146:147], v[178:179], v[114:115], v[146:147] op_sel:[0,0,0] op_sel_hi:[1,0,1]
    v_pk_fma_f32 v[148:149], v[180:181], v[114:115], v[148:149] op_sel:[0,0,0] op_sel_hi:[1,0,1]
    v_pk_fma_f32 v[150:151], v[182:183], v[114:115], v[150:151] op_sel:[0,0,0] op_sel_hi:[1,0,1]
    v_pk_fma_f32 v[152:153], v[184:185], v[114:115], v[152:153] op_sel:[0,0,0] op_sel_hi:[1,0,1]
    v_pk_fma_f32 v[154:155], v[186:187], v[114:115], v[154:155] op_sel:[0,0,0] op_sel_hi:[1,0,1]
    s_waitcnt vmcnt(6)
    v_perm_b32 v64, v190, v188, s70
    v_perm_b32 v68, v190, v188, s71
    v_perm_b32 v72, v191, v189, s70
    v_perm_b32 v76, v191, v189, s71
    s_waitcnt vmcnt(4)
    v_perm_b32 v65, v194, v192, s70
    v_perm_b32 v69, v194, v192, s71
    v_perm_b32 v73, v195, v193, s70
    v_perm_b32 v77, v195, v193, s71
    s_waitcnt vmcnt(2)
    v_perm_b32 v66, v198, v196, s70
    v_perm_b32 v70, v198, v196, s71
    v_perm_b32 v74, v199, v197, s70
    v_perm_b32 v78, v199, v197, s71
    s_waitcnt vmcnt(0)
    v_perm_b32 v67, v202, v200, s70
    v_perm_b32 v71, v202, v200, s71
    v_perm_b32 v75, v203, v201, s70
    v_perm_b32 v79, v203, v201, s71
    v_mfma_f32_16x16x32_bf16 v[188:191], v[64:67], v[216:219], 0
    v_mfma_f32_16x16x32_bf16 v[192:195], v[68:71], v[216:219], 0
    v_mfma_f32_16x16x32_bf16 v[196:199], v[72:75], v[216:219], 0
    v_mfma_f32_16x16x32_bf16 v[200:203], v[76:79], v[216:219], 0
    s_nop 5
    v_pk_fma_f32 v[140:141], v[188:189], v[114:115], v[140:141] op_sel:[0,1,0] op_sel_hi:[1,1,1]
    v_pk_fma_f32 v[142:143], v[190:191], v[114:115], v[142:143] op_sel:[0,1,0] op_sel_hi:[1,1,1]
    v_pk_fma_f32 v[144:145], v[192:193], v[114:115], v[144:145] op_sel:[0,1,0] op_sel_hi:[1,1,1]
    v_pk_fma_f32 v[146:147], v[194:195], v[114:115], v[146:147] op_sel:[0,1,0] op_sel_hi:[1,1,1]
    v_pk_fma_f32 v[148:149], v[196:197], v[114:115], v[148:149] op_sel:[0,1,0] op_sel_hi:[1,1,1]
    v_pk_fma_f32 v[150:151], v[198:199], v[114:115], v[150:151] op_sel:[0,1,0] op_sel_hi:[1,1,1]
    v_pk_fma_f32 v[152:153], v[200:201], v[114:115], v[152:153] op_sel:[0,1,0] op_sel_hi:[1,1,1]
    v_pk_fma_f32 v[154:155], v[202:203], v[114:115], v[154:155] op_sel:[0,1,0] op_sel_hi:[1,1,1]
    v_perm_b32 v224, v140, v152, s20
    v_perm_b32 v225, v144, v152, s21
    v_perm_b32 v226, v148, v152, s22
    v_perm_b32 v228, v141, v153, s20
    v_perm_b32 v229, v145, v153, s21
    v_perm_b32 v230, v149, v153, s22
    v_perm_b32 v232, v142, v154, s20
    v_perm_b32 v233, v146, v154, s21
    v_perm_b32 v234, v150, v154, s22
    v_perm_b32 v236, v143, v155, s20
    v_perm_b32 v237, v147, v155, s21
    v_perm_b32 v238, v151, v155, s22
    s_mov_b32 exec_lo, 0x000f000f
    s_mov_b32 exec_hi, 0x000f000f
    buffer_store_dwordx4 v[224:227], v139, s[8:11], s13 offen offset:0
    buffer_store_dwordx4 v[228:231], v139, s[8:11], s13 offen offset:512
    buffer_store_dwordx4 v[232:235], v139, s[8:11], s13 offen offset:1024
    buffer_store_dwordx4 v[236:239], v139, s[8:11], s13 offen offset:1536
    s_cmp_eq_u32 s14, 0
    s_cselect_b64 s[20:21], 0xf, 0
    s_mov_b64 exec, s[20:21]
    buffer_store_dwordx4 v[220:223], v139, s[8:11], s7 offen
    ds_write_b128 v138, v[220:223] offset:5632
    s_mov_b32 exec_lo, 0x000f000f
    s_mov_b32 exec_hi, 0x000f000f
    ds_write_b128 v138, v[224:227] offset:5120
    ds_write_b128 v138, v[228:231] offset:5136
    ds_write_b128 v138, v[232:235] offset:5152
    ds_write_b128 v138, v[236:239] offset:5168
    s_mov_b64 exec, -1
    s_waitcnt lgkmcnt(0)
    s_barrier
    s_branch L_finx
L_umid:
    s_cmp_ge_u32 s5, 16
    s_cbranch_scc1 L_ucomp
L_uafter:
    buffer_load_dwordx4 v[80:83], v7, s[28:31], 0 offen offset:0 nt
    buffer_load_dwordx4 v[84:87], v7, s[28:31], 0 offen offset:1024 nt
    buffer_load_dwordx4 v[88:91], v7, s[28:31], 0 offen offset:2048 nt
    buffer_load_dwordx4 v[92:95], v7, s[28:31], 0 offen offset:3072 nt
    s_barrier
    s_lshr_b32 s6, s5, 3
    s_cmp_lt_u32 s4, 4
    s_cselect_b32 s7, 4, 3
    s_cmp_ge_u32 s6, s7
    s_cbranch_scc1 L_noffn_16
    s_lshl_b32 s20, s4, 2
    s_add_u32 s20, s20, s6
    s_lshl_b32 s20, s20, 1
    s_add_u32 s20, s20, s3
    s_sub_u32 s20, s20, 4
    s_lshl_b32 s20, s20, 8
    s_add_u32 s20, s20, 655360
    s_mov_b32 s21, 20
    s_add_u32 s22, s8, s20
    s_addc_u32 s23, s9, 0
    s_branch L_f_18
L_frt_22:
    s_sub_u32 s21, s21, 1
    s_cmp_eq_u32 s21, 0
    s_cbranch_scc1 L_fr_21
L_f_18:
    s_load_dwordx16 s[32:47], s[22:23], 0
    s_load_dwordx16 s[48:63], s[22:23], 64
    s_load_dwordx16 s[64:79], s[22:23], 128
    s_load_dwordx16 s[80:95], s[22:23], 192
    s_add_u32 s22, s22, 16384
    s_addc_u32 s23, s23, 0
    s_waitcnt lgkmcnt(0)
    s_cmp_lg_u32 s35, s12
    s_cbranch_scc1 L_frt_22
    s_cmp_lg_u32 s67, s12
    s_cbranch_scc1 L_frt_22
    s_xor_b32 s24, s39, s12
    s_xor_b32 s25, s43, s12
    s_or_b32 s24, s24, s25
    s_xor_b32 s25, s47, s12
    s_or_b32 s24, s24, s25
    s_xor_b32 s25, s51, s12
    s_or_b32 s24, s24, s25
    s_xor_b32 s25, s55, s12
    s_or_b32 s24, s24, s25
    s_xor_b32 s25, s71, s12
    s_or_b32 s24, s24, s25
    s_xor_b32 s25, s75, s12
    s_or_b32 s24, s24, s25
    s_xor_b32 s25, s79, s12
    s_or_b32 s24, s24, s25
    s_xor_b32 s25, s83, s12
    s_or_b32 s24, s24, s25
    s_xor_b32 s25, s87, s12
    s_or_b32 s24, s24, s25
    s_cmp_eq_u32 s24, 0
    s_cbranch_scc0 L_frt_22
L_fok_19:
    v_writelane_b32 v8, s32, 0
    v_writelane_b32 v8, s33, 1
    v_writelane_b32 v8, s34, 2
    v_writelane_b32 v8, s36, 3
    v_writelane_b32 v8, s37, 4
    v_writelane_b32 v8, s38, 5
    v_writelane_b32 v8, s40, 6
    v_writelane_b32 v8, s41, 7
    v_writelane_b32 v8, s42, 8
    v_writelane_b32 v8, s44, 9
    v_writelane_b32 v8, s45, 10
    v_writelane_b32 v8, s46, 11
    v_writelane_b32 v8, s48, 12
    v_writelane_b32 v8, s49, 13
    v_writelane_b32 v8, s50, 14
    v_writelane_b32 v8, s52, 15
    v_writelane_b32 v9, s64, 0
    v_writelane_b32 v9, s65, 1
    v_writelane_b32 v9, s66, 2
    v_writelane_b32 v9, s68, 3
    v_writelane_b32 v9, s69, 4
    v_writelane_b32 v9, s70, 5
    v_writelane_b32 v9, s72, 6
    v_writelane_b32 v9, s73, 7
    v_writelane_b32 v9, s74, 8
    v_writelane_b32 v9, s76, 9
    v_writelane_b32 v9, s77, 10
    v_writelane_b32 v9, s78, 11
    v_writelane_b32 v9, s80, 12
    v_writelane_b32 v9, s81, 13
    v_writelane_b32 v9, s82, 14
    v_writelane_b32 v9, s84, 15
    v_lshlrev_b32 v10, 16, v8
    v_and_b32 v11, 0xffff0000, v8
    v_lshlrev_b32 v12, 16, v9
    v_and_b32 v13, 0xffff0000, v9
    v_mul_f32 v14, 0xbfb8aa3b, v10
    v_mul_f32 v15, 0xbfb8aa3b, v11
    v_exp_f32 v14, v14
    v_exp_f32 v15, v15
    s_nop 0
    v_add_f32 v14, 1.0, v14
    v_add_f32 v15, 1.0, v15
    v_rcp_f32 v14, v14
    v_rcp_f32 v15, v15
    s_nop 0
    v_mul_f32 v14, v10, v14
    v_mul_f32 v15, v11, v15
    v_cvt_pk_bf16_f32 v14, v14, v15
    v_lshlrev_b32 v10, 16, v14
    v_and_b32 v11, 0xffff0000, v14
    v_mul_f32 v10, v10, v12
    v_mul_f32 v11, v11, v13
    v_cvt_pk_bf16_f32 v14, v10, v11
    v_lshrrev_b32 v10, 3, v2
    v_lshlrev_b32 v10, 3, v10
    v_add_u32 v11, 4, v10
    ds_bpermute_b32 v240, v10, v14
    ds_bpermute_b32 v241, v11, v14
    s_waitcnt lgkmcnt(0)
    s_branch L_ffndone_17
L_noffn_16:
    v_mov_b32 v240, 0
    v_mov_b32 v241, 0
L_ffndone_17:
    s_branch L_c3
L_qr_9:
    s_add_u32 s22, s20, 327680
    s_mov_b32 s21, 20000
    v_and_b32 v243, 15, v2
    v_lshlrev_b32 v243, 4, v243
L_qf_8:
    buffer_load_dwordx4 v[244:247], v243, s[8:11], s22 offen sc1
    s_waitcnt vmcnt(0)
    v_readlane_b32 s32, v244, 0
    v_readlane_b32 s33, v245, 0
    v_readlane_b32 s34, v246, 0
    v_readlane_b32 s35, v247, 0
    v_readlane_b32 s36, v244, 1
    v_readlane_b32 s37, v245, 1
    v_readlane_b32 s38, v246, 1
    v_readlane_b32 s39, v247, 1
    v_readlane_b32 s40, v244, 2
    v_readlane_b32 s41, v245, 2
    v_readlane_b32 s42, v246, 2
    v_readlane_b32 s43, v247, 2
    v_readlane_b32 s44, v244, 3
    v_readlane_b32 s45, v245, 3
    v_readlane_b32 s46, v246, 3
    v_readlane_b32 s47, v247, 3
    v_readlane_b32 s48, v244, 4
    v_readlane_b32 s49, v245, 4
    v_readlane_b32 s50, v246, 4
    v_readlane_b32 s51, v247, 4
    v_readlane_b32 s52, v244, 5
    v_readlane_b32 s53, v245, 5
    v_readlane_b32 s54, v246, 5
    v_readlane_b32 s55, v247, 5
    v_readlane_b32 s56, v244, 6
    v_readlane_b32 s57, v245, 6
    v_readlane_b32 s58, v246, 6
    v_readlane_b32 s59, v247, 6
    v_readlane_b32 s60, v244, 7
    v_readlane_b32 s61, v245, 7
    v_readlane_b32 s62, v246, 7
    v_readlane_b32 s63, v247, 7
    v_readlane_b32 s64, v244, 8
    v_readlane_b32 s65, v245, 8
    v_readlane_b32 s66, v246, 8
    v_readlane_b32 s67, v247, 8
    v_readlane_b32 s68, v244, 9
    v_readlane_b32 s69, v245, 9
    v_readlane_b32 s70, v246, 9
    v_readlane_b32 s71, v247, 9
    v_readlane_b32 s72, v244, 10
    v_readlane_b32 s73, v245, 10
    v_readlane_b32 s74, v246, 10
    v_readlane_b32 s75, v247, 10
    v_readlane_b32 s76, v244, 11
    v_readlane_b32 s77, v245, 11
    v_readlane_b32 s78, v246, 11
    v_readlane_b32 s79, v247, 11
    v_readlane_b32 s80, v244, 12
    v_readlane_b32 s81, v245, 12
    v_readlane_b32 s82, v246, 12
    v_readlane_b32 s83, v247, 12
    v_readlane_b32 s84, v244, 13
    v_readlane_b32 s85, v245, 13
    v_readlane_b32 s86, v246, 13
    v_readlane_b32 s87, v247, 13
    v_readlane_b32 s88, v244, 14
    v_readlane_b32 s89, v245, 14
    v_readlane_b32 s90, v246, 14
    v_readlane_b32 s91, v247, 14
    v_readlane_b32 s92, v244, 15
    v_readlane_b32 s93, v245, 15
    v_readlane_b32 s94, v246, 15
    v_readlane_b32 s95, v247, 15
    s_xor_b32 s24, s35, s12
    s_xor_b32 s25, s39, s12
    s_or_b32 s24, s24, s25
    s_xor_b32 s25, s43, s12
    s_or_b32 s24, s24, s25
    s_xor_b32 s25, s47, s12
    s_or_b32 s24, s24, s25
    s_xor_b32 s25, s51, s12
    s_or_b32 s24, s24, s25
    s_xor_b32 s25, s55, s12
    s_or_b32 s24, s24, s25
    s_xor_b32 s25, s59, s12
    s_or_b32 s24, s24, s25
    s_xor_b32 s25, s63, s12
    s_or_b32 s24, s24, s25
    s_xor_b32 s25, s67, s12
    s_or_b32 s24, s24, s25
    s_xor_b32 s25, s71, s12
    s_or_b32 s24, s24, s25
    s_xor_b32 s25, s75, s12
    s_or_b32 s24, s24, s25
    s_xor_b32 s25, s79, s12
    s_or_b32 s24, s24, s25
    s_xor_b32 s25, s83, s12
    s_or_b32 s24, s24, s25
    s_xor_b32 s25, s87, s12
    s_or_b32 s24, s24, s25
    s_xor_b32 s25, s91, s12
    s_or_b32 s24, s24, s25
    s_xor_b32 s25, s95, s12
    s_or_b32 s24, s24, s25
    s_cmp_eq_u32 s24, 0
    s_cbranch_scc1 L_qok_7
    s_sub_u32 s21, s21, 1
    s_cmp_lg_u32 s21, 0
    s_cbranch_scc1 L_qf_8
    s_branch L_qok_7
L_fr_21:
    s_add_u32 s22, s20, 327680
    s_mov_b32 s21, 20000
    v_and_b32 v243, 15, v2
    v_lshlrev_b32 v243, 4, v243
L_ff_20:
    buffer_load_dwordx4 v[244:247], v243, s[8:11], s22 offen sc1
    s_waitcnt vmcnt(0)
    v_readlane_b32 s32, v244, 0
    v_readlane_b32 s33, v245, 0
    v_readlane_b32 s34, v246, 0
    v_readlane_b32 s35, v247, 0
    v_readlane_b32 s36, v244, 1
    v_readlane_b32 s37, v245, 1
    v_readlane_b32 s38, v246, 1
    v_readlane_b32 s39, v247, 1
    v_readlane_b32 s40, v244, 2
    v_readlane_b32 s41, v245, 2
    v_readlane_b32 s42, v246, 2
    v_readlane_b32 s43, v247, 2
    v_readlane_b32 s44, v244, 3
    v_readlane_b32 s45, v245, 3
    v_readlane_b32 s46, v246, 3
    v_readlane_b32 s47, v247, 3
    v_readlane_b32 s48, v244, 4
    v_readlane_b32 s49, v245, 4
    v_readlane_b32 s50, v246, 4
    v_readlane_b32 s51, v247, 4
    v_readlane_b32 s52, v244, 5
    v_readlane_b32 s53, v245, 5
    v_readlane_b32 s54, v246, 5
    v_readlane_b32 s55, v247, 5
    v_readlane_b32 s64, v244, 8
    v_readlane_b32 s65, v245, 8
    v_readlane_b32 s66, v246, 8
    v_readlane_b32 s67, v247, 8
    v_readlane_b32 s68, v244, 9
    v_readlane_b32 s69, v245, 9
    v_readlane_b32 s70, v246, 9
    v_readlane_b32 s71, v247, 9
    v_readlane_b32 s72, v244, 10
    v_readlane_b32 s73, v245, 10
    v_readlane_b32 s74, v246, 10
    v_readlane_b32 s75, v247, 10
    v_readlane_b32 s76, v244, 11
    v_readlane_b32 s77, v245, 11
    v_readlane_b32 s78, v246, 11
    v_readlane_b32 s79, v247, 11
    v_readlane_b32 s80, v244, 12
    v_readlane_b32 s81, v245, 12
    v_readlane_b32 s82, v246, 12
    v_readlane_b32 s83, v247, 12
    v_readlane_b32 s84, v244, 13
    v_readlane_b32 s85, v245, 13
    v_readlane_b32 s86, v246, 13
    v_readlane_b32 s87, v247, 13
    s_xor_b32 s24, s35, s12
    s_xor_b32 s25, s39, s12
    s_or_b32 s24, s24, s25
    s_xor_b32 s25, s43, s12
    s_or_b32 s24, s24, s25
    s_xor_b32 s25, s47, s12
    s_or_b32 s24, s24, s25
    s_xor_b32 s25, s51, s12
    s_or_b32 s24, s24, s25
    s_xor_b32 s25, s55, s12
    s_or_b32 s24, s24, s25
    s_xor_b32 s25, s67, s12
    s_or_b32 s24, s24, s25
    s_xor_b32 s25, s71, s12
    s_or_b32 s24, s24, s25
    s_xor_b32 s25, s75, s12
    s_or_b32 s24, s24, s25
    s_xor_b32 s25, s79, s12
    s_or_b32 s24, s24, s25
    s_xor_b32 s25, s83, s12
    s_or_b32 s24, s24, s25
    s_xor_b32 s25, s87, s12
    s_or_b32 s24, s24, s25
    s_cmp_eq_u32 s24, 0
    s_cbranch_scc1 L_fok_19
    s_sub_u32 s21, s21, 1
    s_cmp_lg_u32 s21, 0
    s_cbranch_scc1 L_ff_20
    s_branch L_fok_19
L_osf_26:
    s_cmp_lg_u32 s99, 1
    s_cbranch_scc1 L_nocp_31
    s_mov_b32 exec_hi, 1
    buffer_store_dwordx4 v[32:35], v5, s[8:11], s26 offen sc1
    s_mov_b32 exec_hi, -1
    s_mov_b32 s99, 0
L_nocp_31:
    v_lshlrev_b32 v13, 6, v13
    v_lshrrev_b32 v12, 3, v2
    v_lshl_add_u32 v12, v12, 4, v13
    s_lshl_b32 s7, s3, 7
    s_sub_u32 s6, 512, s7
    v_add_u32 v13, s6, v13
    s_add_u32 s20, s22, s7
    s_add_u32 s20, s20, 4194304
    s_add_u32 s21, s20, 8192
    s_add_u32 s22, s20, 16384
    s_add_u32 s23, s20, 24576
L_osb_25:
    buffer_load_dwordx4 v[100:103], v12, s[8:11], s20 offen sc1
    buffer_load_dwordx4 v[104:107], v12, s[8:11], s21 offen sc1
    buffer_load_dwordx4 v[108:111], v12, s[8:11], s22 offen sc1
    buffer_load_dwordx4 v[112:115], v12, s[8:11], s23 offen sc1
    buffer_load_dwordx4 v[116:119], v13, s[8:11], s20 offen sc1
    buffer_load_dwordx4 v[120:123], v13, s[8:11], s21 offen sc1
    buffer_load_dwordx4 v[124:127], v13, s[8:11], s22 offen sc1
    buffer_load_dwordx4 v[128:131], v13, s[8:11], s23 offen sc1
    s_mov_b32 s6, 0x04000c0c
    s_mov_b32 s7, 0x0706000c
    s_waitcnt vmcnt(0)
    v_xor_b32 v10, s12, v103
    v_xor_b32 v11, s12, v107
    v_or_b32 v10, v10, v11
    v_xor_b32 v11, s12, v111
    v_or_b32 v10, v10, v11
    v_xor_b32 v11, s12, v115
    v_or_b32 v10, v10, v11
    v_xor_b32 v11, s12, v119
    v_or_b32 v10, v10, v11
    v_xor_b32 v11, s12, v123
    v_or_b32 v10, v10, v11
    v_xor_b32 v11, s12, v127
    v_or_b32 v10, v10, v11
    v_xor_b32 v11, s12, v131
    v_or_b32 v10, v10, v11
    v_cmp_ne_u32 vcc, 0, v10
    s_nop 1
    s_cmp_eq_u64 vcc, 0
    s_cbranch_scc1 L_osok_24
    s_sub_u32 s24, s24, 1
    s_cmp_lg_u32 s24, 0
    s_cbranch_scc1 L_osb_25
    s_branch L_osok_24
L_codeend:
    s_endpgm
.section .rodata,"a"
.p2align 6
.amdhsa_kernel parallel_sum__sliding_block_cached__glu_gated_swiglu__decode_kernel
  .amdhsa_next_free_vgpr 256
  .amdhsa_next_free_sgpr 102
  .amdhsa_accum_offset 256
  .amdhsa_group_segment_fixed_size 0
  .amdhsa_kernarg_size 96
  .amdhsa_user_sgpr_count 2
  .amdhsa_user_sgpr_kernarg_segment_ptr 1
  .amdhsa_system_sgpr_workgroup_id_x 1
.end_amdhsa_kernel
```
